```python
import torch

def _softmax(x, axis=-1):
    return torch.softmax(x, dim=axis)
def _gelu(x):
    return torch.nn.functional.gelu(x, approximate="tanh")
def _silu(x):
    return torch.nn.functional.silu(x)
def _sigmoid(x):
    return torch.sigmoid(x)
def _layernorm(x, axis=-1, eps=1e-5):
    m = x.mean(dim=axis, keepdim=True)
    v = x.var(dim=axis, keepdim=True, unbiased=False)
    return (x - m) / torch.sqrt(v + eps)
def _scatter_add(tgt, idx, src, axis=0):
    return tgt.clone().index_add_(axis, idx, src)
def _segment_sum(src, seg, n):
    out = torch.zeros((n,) + src.shape[1:], dtype=src.dtype)
    return out.index_add_(0, seg, src)
def _pad(x, pw):
    flat = tuple(v for pair in reversed(pw) for v in pair)
    return torch.nn.functional.pad(x, flat)

kernel_name = 'recurrent_scan__ssm_conv_s5__dense_activation_relu__prompt'

def setup_inputs():

    _w = (lambda a: (lambda t: t.to(torch.bfloat16) if t.is_floating_point() else t)(torch.as_tensor(a)))
    def _A_setup():
        B, S, D = 1, 2048, 640
        P = D
        Lambda_re = -0.5 * (lambda _x: torch.exp(torch.as_tensor(_x)))((lambda *s: torch.randn(*s, dtype=torch.bfloat16) * 0.2)(P))
        Lambda_im = (lambda *s: torch.randn(*s, dtype=torch.bfloat16) * 0.4)(P) * 1.0
        B_re = (lambda *s: torch.randn(*s, dtype=torch.bfloat16) * 0.2)(P, D) * (D ** -0.5)
        B_im = (lambda *s: torch.randn(*s, dtype=torch.bfloat16) * 0.2)(P, D) * (D ** -0.5)
        C_re = (lambda *s: torch.randn(*s, dtype=torch.bfloat16) * 0.2)(D, P) * (P ** -0.5)
        C_im = (lambda *s: torch.randn(*s, dtype=torch.bfloat16) * 0.2)(D, P) * (P ** -0.5)
        log_dt = (lambda *s: torch.randn(*s, dtype=torch.bfloat16) * 0.2)(P) * 0.3 - 2.0
        Dskip = (lambda *s: torch.randn(*s, dtype=torch.bfloat16) * 0.05)(D)
        return {
            "x": _w((lambda *s: torch.randn(*s, dtype=torch.bfloat16) * 0.05)(B, S, D)),
            "Lambda_re": _w(Lambda_re),
            "Lambda_im": _w(Lambda_im),
            "B_re": _w(B_re),
            "B_im": _w(B_im),
            "C_re": _w(C_re),
            "C_im": _w(C_im),
            "log_dt": _w(log_dt),
            "Dskip": _w(Dskip),
        }
    _A_in = _A_setup()

    def _B_setup():
        B, S, D, Dff = 1, 2048, 640, 1728
        return {
            "x": _w((lambda *s: torch.randn(*s, dtype=torch.bfloat16) * 0.05)(B, S, D)),
            "w1": _w((lambda *s: torch.randn(*s, dtype=torch.bfloat16) * 0.05)(D, Dff)),
            "w2": _w((lambda *s: torch.randn(*s, dtype=torch.bfloat16) * 0.05)(Dff, D)),
        }
    _B_in = _B_setup()

    return {
        "A_x": _A_in["x"],
        "A_Lambda_re": _A_in["Lambda_re"],
        "A_Lambda_im": _A_in["Lambda_im"],
        "A_B_re": _A_in["B_re"],
        "A_B_im": _A_in["B_im"],
        "A_C_re": _A_in["C_re"],
        "A_C_im": _A_in["C_im"],
        "A_log_dt": _A_in["log_dt"],
        "A_Dskip": _A_in["Dskip"],
        "B_x": _B_in["x"],
        "B_w1": _B_in["w1"],
        "B_w2": _B_in["w2"],
    }

def reference(A_x, A_Lambda_re, A_Lambda_im, A_B_re, A_B_im, A_C_re, A_C_im, A_log_dt, A_Dskip, B_x, B_w1, B_w2):
    def _A_ref(x, Lambda_re, Lambda_im, B_re, B_im, C_re, C_im, log_dt, Dskip):
        Bsz, L, H = x.shape
        Lam = Lambda_re + 1j * Lambda_im
        Bmat = B_re + 1j * B_im
        Cmat = C_re + 1j * C_im
        dt = torch.exp(log_dt)
        Lam_bar = torch.exp(dt * Lam)
        B_bar = ((Lam_bar - 1.0) / Lam)[:, None] * Bmat
        Bu = torch.einsum("bld,pd->blp", x + 0j, B_bar)
        h = torch.zeros_like(Bu[:, 0, :])
        hs = []
        for t in range(L):
            h = Lam_bar[None, :] * h + Bu[:, t, :]
            hs.append(h)
        hseq = torch.stack(hs, 1)
        y = 2.0 * torch.einsum("blp,dp->bld", hseq, Cmat).real + x * Dskip[None, None, :]
        return y

    def _B_ref(x, w1, w2):
        h = torch.einsum("bsd,df->bsf", x, w1)
        zero = torch.zeros_like(h)
        h = torch.maximum(h, zero)
        return torch.einsum("bsf,fd->bsd", h, w2)

    x = A_x
    xn = _layernorm(x, axis=-1)
    s = _A_ref(xn, A_Lambda_re, A_Lambda_im, A_B_re, A_B_im, A_C_re, A_C_im, A_log_dt, A_Dskip)
    g = _silu(_B_ref(xn, B_w1, B_w2))
    return x + s * g
```

```asm
; @launch kernel=k0_kernel grid=(259,1,1) block=(256,1,1) lds=0
; @launch kernel=k1_kernel grid=(256,1,1) block=(512,1,1) lds=163840
; @launch kernel=k2_kernel grid=(256,1,1) block=(512,1,1) lds=159744
.amdgcn_target "amdgcn-amd-amdhsa--gfx950"
.text
.globl k0_kernel
.p2align 8
.type k0_kernel,@function
k0_kernel:
    s_cmp_ge_u32 s2, 259
    s_cbranch_scc1 k0_done
    s_load_dwordx2 s[4:5], s[0:1], 0
    s_load_dwordx2 s[6:7], s[0:1], 112
    s_load_dwordx2 s[40:41], s[0:1], 24
    s_load_dwordx2 s[42:43], s[0:1], 32
    s_load_dwordx2 s[44:45], s[0:1], 80
    s_load_dwordx2 s[60:61], s[0:1], 40
    s_load_dwordx2 s[62:63], s[0:1], 48
    s_load_dwordx2 s[36:37], s[0:1], 88
    s_cmp_ge_u32 s2, 256
    s_cbranch_scc1 k0_params
    v_lshrrev_b32 v1, 5, v0
    v_and_b32 v2, 31, v0
    s_lshl_b32 s3, s2, 3
    v_add_u32 v1, s3, v1
    v_mul_u32_u24 v1, 1280, v1
    v_lshl_add_u32 v1, v2, 3, v1
    v_lshrrev_b32 v52, 5, v0
    s_and_b32 s26, s2, 15
    s_lshl_b32 s26, s26, 3
    v_add_u32 v52, s26, v52
    v_and_b32 v53, 64, v52
    v_bfe_u32 v54, v52, 1, 2
    v_lshl_add_u32 v53, v54, 4, v53
    v_bfe_u32 v54, v52, 4, 2
    v_lshl_add_u32 v53, v54, 2, v53
    v_bfe_u32 v54, v52, 3, 1
    v_add_u32 v53, v53, v54
    v_and_b32 v54, 1, v52
    v_lshl_add_u32 v53, v54, 1, v53
    v_bfe_u32 v54, v53, 1, 3
    v_bfe_u32 v55, v2, 1, 3
    v_xor_b32 v54, v54, v55
    v_lshlrev_b32 v54, 4, v54
    v_lshl_add_u32 v3, v53, 7, v54
    v_and_b32 v54, 1, v2
    v_lshl_add_u32 v3, v54, 3, v3
    v_lshrrev_b32 v54, 4, v2
    v_lshl_add_u32 v3, v54, 14, v3
    s_lshr_b32 s26, s2, 4
    s_mul_i32 s26, s26, 163840
    v_add_u32 v3, s26, v3
    v_lshlrev_b32 v55, 3, v2
    s_waitcnt lgkmcnt(0)
    s_mov_b32 s8, s4
    s_mov_b32 s9, s5
    s_mov_b32 s10, 2621440
    s_mov_b32 s11, 0x00020000
    s_mov_b32 s12, s6
    s_mov_b32 s13, s7
    s_mov_b32 s14, 2621440
    s_mov_b32 s15, 0x00020000
    s_add_u32 s16, s6, 14979072
    s_addc_u32 s17, s7, 0
    s_mov_b32 s18, 114688
    s_mov_b32 s19, 0x00020000
    s_add_u32 s32, s6, 2621440
    s_addc_u32 s33, s7, 0
    s_mov_b32 s34, 16384
    s_mov_b32 s35, 0x00020000
    buffer_load_dwordx2 v[4:5], v1, s[8:11], 0 offen offset:0
    buffer_load_dwordx2 v[6:7], v1, s[8:11], 0 offen offset:256
    buffer_load_dwordx2 v[8:9], v1, s[8:11], 0 offen offset:512
    buffer_load_dwordx2 v[10:11], v1, s[8:11], 0 offen offset:768
    buffer_load_dwordx2 v[12:13], v1, s[8:11], 0 offen offset:1024
    v_lshrrev_b32 v66, 6, v0
    s_lshl_b32 s46, s2, 2
    v_add_u32 v66, s46, v66
    v_and_b32 v67, 63, v0
    s_mov_b32 s48, s44
    s_mov_b32 s49, s45
    s_mov_b32 s50, 2211840
    s_mov_b32 s51, 0x00020000
    s_mov_b32 s52, s40
    s_mov_b32 s53, s41
    s_mov_b32 s54, 819200
    s_mov_b32 s55, 0x00020000
    s_mov_b32 s56, s42
    s_mov_b32 s57, s43
    s_mov_b32 s58, 819200
    s_mov_b32 s59, 0x00020000
    v_min_u32 v68, 6, v67
    v_mul_u32_u24 v69, 7, v66
    v_add_u32 v68, v68, v69
    v_lshlrev_b32 v68, 7, v68
    buffer_load_dword v70, v68, s[52:55], 0 offen
    buffer_load_dword v71, v68, s[56:59], 0 offen
    s_mov_b32 s52, s60
    s_mov_b32 s53, s61
    s_mov_b32 s54, 819200
    s_mov_b32 s55, 0x00020000
    s_mov_b32 s56, s62
    s_mov_b32 s57, s63
    s_mov_b32 s58, 819200
    s_mov_b32 s59, 0x00020000
    buffer_load_dword v73, v68, s[52:55], 0 offen
    buffer_load_dword v74, v68, s[56:59], 0 offen
    v_min_u32 v68, 16, v67
    v_mul_u32_u24 v69, 17, v66
    v_add_u32 v68, v68, v69
    v_lshlrev_b32 v68, 7, v68
    buffer_load_dword v72, v68, s[48:51], 0 offen
    s_mov_b32 s48, s36
    s_mov_b32 s49, s37
    s_mov_b32 s50, 2211840
    s_mov_b32 s51, 0x00020000
    buffer_load_dword v75, v68, s[48:51], 0 offen
    s_waitcnt vmcnt(6)
    v_lshlrev_b32 v20, 16, v4
    v_and_b32 v21, 0xffff0000, v4
    v_lshlrev_b32 v22, 16, v5
    v_and_b32 v23, 0xffff0000, v5
    v_lshlrev_b32 v24, 16, v6
    v_and_b32 v25, 0xffff0000, v6
    v_lshlrev_b32 v26, 16, v7
    v_and_b32 v27, 0xffff0000, v7
    v_lshlrev_b32 v28, 16, v8
    v_and_b32 v29, 0xffff0000, v8
    v_lshlrev_b32 v30, 16, v9
    v_and_b32 v31, 0xffff0000, v9
    v_lshlrev_b32 v32, 16, v10
    v_and_b32 v33, 0xffff0000, v10
    v_lshlrev_b32 v34, 16, v11
    v_and_b32 v35, 0xffff0000, v11
    v_lshlrev_b32 v36, 16, v12
    v_and_b32 v37, 0xffff0000, v12
    v_lshlrev_b32 v38, 16, v13
    v_and_b32 v39, 0xffff0000, v13
    s_lshr_b32 s46, s2, 3
    s_cmp_ge_u32 s46, 2
    s_cbranch_scc1 k0_cpf_1
    s_getpc_b64 s[50:51]
k0_pc:
    s_add_u32 s50, s50, k1_kernel-k0_pc
    s_addc_u32 s51, s51, 0
    s_lshl_b32 s46, s46, 15
    v_lshlrev_b32 v76, 7, v0
    v_add_u32 v76, s46, v76
    v_min_u32 v76, code_end-k1_kernel-4, v76
    v_mov_b32 v79, s51
    v_add_co_u32 v78, vcc, s50, v76
    s_nop 1
    v_addc_co_u32 v79, vcc, 0, v79, vcc
    global_load_dword v77, v[78:79], off
k0_cpf_1:
    s_mul_i32 s20, s2, 320
    s_lshl_b32 s21, s2, 7
    s_add_u32 s21, s21, 81600
    v_lshlrev_b32 v44, 4, v0
    v_add_u32 v45, s21, v44
    v_add_u32 v44, s20, v44
    v_cmp_gt_u32 vcc, 20, v0
    s_nop 1
    v_cndmask_b32 v44, v45, v44, vcc
    v_cndmask_b32 v48, 0, -1, vcc
    v_mov_b32 v49, v48
    v_mov_b32 v50, v48
    v_mov_b32 v51, v48
    v_cmp_gt_u32 vcc, 28, v0
    s_and_saveexec_b64 s[22:23], vcc
    s_cbranch_execz k0_noinit
    buffer_store_dwordx4 v[48:51], v44, s[16:19], 0 offen
k0_noinit:
    s_mov_b64 exec, s[22:23]
    v_add_f32 v40, v20, v21
    v_add_f32 v41, v22, v23
    v_add_f32 v40, v40, v24
    v_add_f32 v40, v40, v25
    v_add_f32 v41, v41, v26
    v_add_f32 v41, v41, v27
    v_add_f32 v40, v40, v28
    v_add_f32 v40, v40, v29
    v_add_f32 v41, v41, v30
    v_add_f32 v41, v41, v31
    v_add_f32 v40, v40, v32
    v_add_f32 v40, v40, v33
    v_add_f32 v41, v41, v34
    v_add_f32 v41, v41, v35
    v_add_f32 v40, v40, v36
    v_add_f32 v40, v40, v37
    v_add_f32 v41, v41, v38
    v_add_f32 v41, v41, v39
    v_add_f32 v40, v40, v41
    s_nop 1
    v_add_f32_dpp v40, v40, v40 row_ror:8 row_mask:0xf bank_mask:0xf
    s_nop 1
    v_add_f32_dpp v40, v40, v40 row_ror:4 row_mask:0xf bank_mask:0xf
    s_nop 1
    v_add_f32_dpp v40, v40, v40 row_ror:2 row_mask:0xf bank_mask:0xf
    s_nop 1
    v_add_f32_dpp v40, v40, v40 row_ror:1 row_mask:0xf bank_mask:0xf
    v_mov_b32 v41, v40
    s_nop 1
    v_permlane16_swap_b32 v40, v41
    s_nop 1
    v_add_f32 v40, v40, v41
    v_mul_f32 v40, 0x3acccccd, v40
    v_mov_b32 v42, 0
    v_mov_b32 v43, 0
    v_sub_f32 v4, v20, v40
    v_fmac_f32 v42, v4, v4
    v_sub_f32 v5, v21, v40
    v_fmac_f32 v43, v5, v5
    v_sub_f32 v6, v22, v40
    v_fmac_f32 v42, v6, v6
    v_sub_f32 v7, v23, v40
    v_fmac_f32 v43, v7, v7
    v_sub_f32 v4, v24, v40
    v_fmac_f32 v42, v4, v4
    v_sub_f32 v5, v25, v40
    v_fmac_f32 v43, v5, v5
    v_sub_f32 v6, v26, v40
    v_fmac_f32 v42, v6, v6
    v_sub_f32 v7, v27, v40
    v_fmac_f32 v43, v7, v7
    v_sub_f32 v4, v28, v40
    v_fmac_f32 v42, v4, v4
    v_sub_f32 v5, v29, v40
    v_fmac_f32 v43, v5, v5
    v_sub_f32 v6, v30, v40
    v_fmac_f32 v42, v6, v6
    v_sub_f32 v7, v31, v40
    v_fmac_f32 v43, v7, v7
    v_sub_f32 v4, v32, v40
    v_fmac_f32 v42, v4, v4
    v_sub_f32 v5, v33, v40
    v_fmac_f32 v43, v5, v5
    v_sub_f32 v6, v34, v40
    v_fmac_f32 v42, v6, v6
    v_sub_f32 v7, v35, v40
    v_fmac_f32 v43, v7, v7
    v_sub_f32 v4, v36, v40
    v_fmac_f32 v42, v4, v4
    v_sub_f32 v5, v37, v40
    v_fmac_f32 v43, v5, v5
    v_sub_f32 v6, v38, v40
    v_fmac_f32 v42, v6, v6
    v_sub_f32 v7, v39, v40
    v_fmac_f32 v43, v7, v7
    v_add_f32 v42, v42, v43
    s_nop 1
    v_add_f32_dpp v42, v42, v42 row_ror:8 row_mask:0xf bank_mask:0xf
    s_nop 1
    v_add_f32_dpp v42, v42, v42 row_ror:4 row_mask:0xf bank_mask:0xf
    s_nop 1
    v_add_f32_dpp v42, v42, v42 row_ror:2 row_mask:0xf bank_mask:0xf
    s_nop 1
    v_add_f32_dpp v42, v42, v42 row_ror:1 row_mask:0xf bank_mask:0xf
    v_mov_b32 v43, v42
    s_nop 1
    v_permlane16_swap_b32 v42, v43
    s_nop 1
    v_add_f32 v42, v42, v43
    v_mul_f32 v42, 0x3acccccd, v42
    v_cvt_pk_bf16_f32 v40, v40, v40
    v_lshlrev_b32 v40, 16, v40
    v_cvt_pk_bf16_f32 v42, v42, v42
    v_lshlrev_b32 v42, 16, v42
    v_add_f32 v42, 0x3727c5ac, v42
    v_cvt_pk_bf16_f32 v42, v42, v42
    v_lshlrev_b32 v42, 16, v42
    v_sqrt_f32 v42, v42
    s_nop 0
    v_cvt_pk_bf16_f32 v42, v42, v42
    v_lshlrev_b32 v42, 16, v42
    v_rcp_f32 v42, v42
    s_nop 0
    v_sub_f32 v20, v20, v40
    v_sub_f32 v21, v21, v40
    v_cvt_pk_bf16_f32 v4, v20, v21
    v_lshlrev_b32 v20, 16, v4
    v_and_b32 v21, 0xffff0000, v4
    v_mul_f32 v20, v20, v42
    v_mul_f32 v21, v21, v42
    v_cvt_pk_bf16_f32 v4, v20, v21
    v_sub_f32 v22, v22, v40
    v_sub_f32 v23, v23, v40
    v_cvt_pk_bf16_f32 v5, v22, v23
    v_lshlrev_b32 v22, 16, v5
    v_and_b32 v23, 0xffff0000, v5
    v_mul_f32 v22, v22, v42
    v_mul_f32 v23, v23, v42
    v_cvt_pk_bf16_f32 v5, v22, v23
    v_sub_f32 v24, v24, v40
    v_sub_f32 v25, v25, v40
    v_cvt_pk_bf16_f32 v6, v24, v25
    v_lshlrev_b32 v24, 16, v6
    v_and_b32 v25, 0xffff0000, v6
    v_mul_f32 v24, v24, v42
    v_mul_f32 v25, v25, v42
    v_cvt_pk_bf16_f32 v6, v24, v25
    v_sub_f32 v26, v26, v40
    v_sub_f32 v27, v27, v40
    v_cvt_pk_bf16_f32 v7, v26, v27
    v_lshlrev_b32 v26, 16, v7
    v_and_b32 v27, 0xffff0000, v7
    v_mul_f32 v26, v26, v42
    v_mul_f32 v27, v27, v42
    v_cvt_pk_bf16_f32 v7, v26, v27
    v_sub_f32 v28, v28, v40
    v_sub_f32 v29, v29, v40
    v_cvt_pk_bf16_f32 v8, v28, v29
    v_lshlrev_b32 v28, 16, v8
    v_and_b32 v29, 0xffff0000, v8
    v_mul_f32 v28, v28, v42
    v_mul_f32 v29, v29, v42
    v_cvt_pk_bf16_f32 v8, v28, v29
    v_sub_f32 v30, v30, v40
    v_sub_f32 v31, v31, v40
    v_cvt_pk_bf16_f32 v9, v30, v31
    v_lshlrev_b32 v30, 16, v9
    v_and_b32 v31, 0xffff0000, v9
    v_mul_f32 v30, v30, v42
    v_mul_f32 v31, v31, v42
    v_cvt_pk_bf16_f32 v9, v30, v31
    v_sub_f32 v32, v32, v40
    v_sub_f32 v33, v33, v40
    v_cvt_pk_bf16_f32 v10, v32, v33
    v_lshlrev_b32 v32, 16, v10
    v_and_b32 v33, 0xffff0000, v10
    v_mul_f32 v32, v32, v42
    v_mul_f32 v33, v33, v42
    v_cvt_pk_bf16_f32 v10, v32, v33
    v_sub_f32 v34, v34, v40
    v_sub_f32 v35, v35, v40
    v_cvt_pk_bf16_f32 v11, v34, v35
    v_lshlrev_b32 v34, 16, v11
    v_and_b32 v35, 0xffff0000, v11
    v_mul_f32 v34, v34, v42
    v_mul_f32 v35, v35, v42
    v_cvt_pk_bf16_f32 v11, v34, v35
    v_sub_f32 v36, v36, v40
    v_sub_f32 v37, v37, v40
    v_cvt_pk_bf16_f32 v12, v36, v37
    v_lshlrev_b32 v36, 16, v12
    v_and_b32 v37, 0xffff0000, v12
    v_mul_f32 v36, v36, v42
    v_mul_f32 v37, v37, v42
    v_cvt_pk_bf16_f32 v12, v36, v37
    v_sub_f32 v38, v38, v40
    v_sub_f32 v39, v39, v40
    v_cvt_pk_bf16_f32 v13, v38, v39
    v_lshlrev_b32 v38, 16, v13
    v_and_b32 v39, 0xffff0000, v13
    v_mul_f32 v38, v38, v42
    v_mul_f32 v39, v39, v42
    v_cvt_pk_bf16_f32 v13, v38, v39
    s_mov_b32 s26, 0
    buffer_store_dwordx2 v[4:5], v3, s[12:15], s26 offen sc1
    s_mov_b32 s26, 32768
    buffer_store_dwordx2 v[6:7], v3, s[12:15], s26 offen sc1
    s_mov_b32 s26, 65536
    buffer_store_dwordx2 v[8:9], v3, s[12:15], s26 offen sc1
    s_mov_b32 s26, 98304
    buffer_store_dwordx2 v[10:11], v3, s[12:15], s26 offen sc1
    s_mov_b32 s26, 131072
    buffer_store_dwordx2 v[12:13], v3, s[12:15], s26 offen sc1
    v_mov_b32 v41, v42
    v_lshrrev_b32 v44, 5, v0
    s_lshl_b32 s26, s2, 3
    v_add_u32 v44, s26, v44
    v_lshlrev_b32 v44, 3, v44
    v_cmp_eq_u32 vcc, 0, v2
    s_and_saveexec_b64 s[22:23], vcc
    buffer_store_dwordx2 v[40:41], v44, s[32:35], 0 offen
    s_mov_b64 exec, s[22:23]
    s_endpgm
k0_params:
    s_load_dwordx2 s[24:25], s[0:1], 8
    s_load_dwordx2 s[26:27], s[0:1], 16
    s_load_dwordx2 s[28:29], s[0:1], 56
    s_load_dwordx2 s[30:31], s[0:1], 64
    s_sub_u32 s3, s2, 256
    s_lshl_b32 s3, s3, 8
    v_add_u32 v1, s3, v0
    v_lshlrev_b32 v2, 1, v1
    s_waitcnt lgkmcnt(0)
    s_mov_b32 s8, s24
    s_mov_b32 s9, s25
    s_mov_b32 s10, 1280
    s_mov_b32 s11, 0x00020000
    s_mov_b32 s12, s26
    s_mov_b32 s13, s27
    s_mov_b32 s14, 1280
    s_mov_b32 s15, 0x00020000
    s_mov_b32 s16, s28
    s_mov_b32 s17, s29
    s_mov_b32 s18, 1280
    s_mov_b32 s19, 0x00020000
    s_add_u32 s20, s6, 14958592
    s_addc_u32 s21, s7, 0
    s_mov_b32 s22, 20480
    s_mov_b32 s23, 0x00020000
    buffer_load_ushort v4, v2, s[8:11], 0 offen
    buffer_load_ushort v5, v2, s[12:15], 0 offen
    buffer_load_ushort v6, v2, s[16:19], 0 offen
    s_mov_b32 s32, s30
    s_mov_b32 s33, s31
    s_mov_b32 s34, 1280
    s_mov_b32 s35, 0x00020000
    buffer_load_ushort v30, v2, s[32:35], 0 offen
    s_waitcnt vmcnt(0)
    v_lshlrev_b32 v4, 16, v4
    v_lshlrev_b32 v5, 16, v5
    v_lshlrev_b32 v6, 16, v6
    v_mul_f32 v6, 0x3fb8aa3b, v6
    v_exp_f32 v6, v6
    s_nop 0
    v_cvt_pk_bf16_f32 v6, v6, v6
    v_lshlrev_b32 v6, 16, v6
    v_mul_f32 v7, v6, v4
    v_mul_f32 v8, v6, v5
    v_mul_f32 v7, 0x3fb8aa3b, v7
    v_exp_f32 v7, v7
    v_mul_f32 v8, 0.15915494309189535, v8
    v_fract_f32 v8, v8
    v_sin_f32 v9, v8
    v_cos_f32 v10, v8
    s_nop 0
    v_mul_f32 v12, v7, v10
    v_mul_f32 v13, v7, v9
    v_subrev_f32 v20, 1.0, v12
    v_mul_f32 v21, v4, v4
    v_fmac_f32 v21, v5, v5
    v_rcp_f32 v21, v21
    s_nop 0
    v_add_f32 v21, v21, v21
    v_mul_f32 v18, v20, v4
    v_fmac_f32 v18, v13, v5
    v_mul_f32 v19, v13, v4
    v_fma_f32 v19, -v20, v5, v19
    v_mul_f32 v18, v18, v21
    v_mul_f32 v19, v19, v21
    v_sub_f32 v13, 0, v13
    v_mov_b32 v22, v12
    v_mov_b32 v23, v13
    v_mul_f32 v24, v22, v22
    v_fma_f32 v24, -v23, v23, v24
    v_mul_f32 v25, v22, v23
    v_add_f32 v23, v25, v25
    v_mov_b32 v22, v24
    v_mul_f32 v24, v22, v22
    v_fma_f32 v24, -v23, v23, v24
    v_mul_f32 v25, v22, v23
    v_add_f32 v23, v25, v25
    v_mov_b32 v22, v24
    v_mul_f32 v24, v22, v22
    v_fma_f32 v24, -v23, v23, v24
    v_mul_f32 v25, v22, v23
    v_add_f32 v23, v25, v25
    v_mov_b32 v22, v24
    v_mov_b32 v14, v22
    v_mov_b32 v15, v23
    v_mul_f32 v24, v22, v22
    v_fma_f32 v24, -v23, v23, v24
    v_mul_f32 v25, v22, v23
    v_add_f32 v23, v25, v25
    v_mov_b32 v22, v24
    v_mul_f32 v24, v22, v22
    v_fma_f32 v24, -v23, v23, v24
    v_mul_f32 v25, v22, v23
    v_add_f32 v23, v25, v25
    v_mov_b32 v22, v24
    v_mul_f32 v24, v22, v22
    v_fma_f32 v24, -v23, v23, v24
    v_mul_f32 v25, v22, v23
    v_add_f32 v23, v25, v25
    v_mov_b32 v22, v24
    v_mul_f32 v24, v22, v22
    v_fma_f32 v24, -v23, v23, v24
    v_mul_f32 v25, v22, v23
    v_add_f32 v23, v25, v25
    v_mov_b32 v22, v24
    v_mov_b32 v16, v22
    v_mov_b32 v17, v23
    v_lshlrev_b32 v2, 5, v1
    buffer_store_dwordx4 v[12:15], v2, s[20:23], 0 offen
    buffer_store_dwordx4 v[16:19], v2, s[20:23], 0 offen offset:16
    s_endpgm
k0_done:
    s_endpgm
.globl k1_kernel
.p2align 8
.type k1_kernel,@function
k1_kernel:
    s_cmp_ge_u32 s2, 256
    s_cbranch_scc1 k1_done
    s_load_dwordx2 s[4:5], s[0:1], 112
    s_load_dwordx2 s[6:7], s[0:1], 24
    s_load_dwordx2 s[30:31], s[0:1], 32
    s_load_dwordx2 s[32:33], s[0:1], 80
    s_load_dwordx2 s[56:57], s[0:1], 40
    s_load_dwordx2 s[58:59], s[0:1], 48
    s_load_dwordx2 s[60:61], s[0:1], 88
    v_lshrrev_b32 v1, 6, v0
    s_and_b32 s49, s2, 7
    s_lshr_b32 s50, s2, 3
    v_readfirstlane_b32 s42, v1
    s_and_b32 s40, s49, 3
    s_lshl_b32 s40, s40, 2
    s_and_b32 s51, s50, 3
    s_add_u32 s40, s40, s51
    s_lshr_b32 s50, s50, 2
    s_lshr_b32 s49, s49, 2
    s_mul_i32 s41, s49, 5
    s_add_u32 s41, s41, s50
    s_mul_i32 s51, s49, 3
    s_add_u32 s51, s51, s50
    s_add_u32 s51, s51, 5
    s_cmp_ge_u32 s50, 5
    s_cselect_b32 s41, s51, s41
    s_cmp_ge_u32 s42, 4
    s_cbranch_scc1 k1_loader
    s_and_b32 s52, s42, 1
    s_lshr_b32 s53, s42, 1
    v_and_b32 v1, 63, v0
    v_lshrrev_b32 v14, 4, v1
    v_and_b32 v15, 15, v1
    v_lshrrev_b32 v16, 1, v15
    v_xor_b32 v16, v16, v14
    v_lshlrev_b32 v16, 4, v16
    v_lshl_add_u32 v16, v15, 7, v16
    s_lshl_b32 s49, s52, 13
    v_add_u32 v2, s49, v16
    v_xor_b32 v3, 64, v2
    v_bfe_u32 v17, v15, 1, 1
    v_lshrrev_b32 v18, 3, v15
    v_lshlrev_b32 v18, 1, v18
    v_lshrrev_b32 v19, 1, v14
    v_add_u32 v18, v18, v19
    v_xor_b32 v17, v17, v18
    v_lshlrev_b32 v17, 5, v17
    v_and_b32 v18, 1, v14
    v_lshl_add_u32 v17, v18, 4, v17
    v_and_b32 v18, 7, v15
    v_lshl_add_u32 v17, v18, 7, v17
    s_lshl_b32 s49, s40, 1
    s_add_u32 s49, s49, s52
    s_mul_i32 s49, s49, 385024
    v_add_u32 v17, s49, v17
    s_cmp_ge_u32 s41, 10
    s_cbranch_scc1 k1_ffn
    s_lshl_b32 s49, s53, 13
    s_add_u32 s49, s49, 16384
    v_add_u32 v4, s49, v16
    v_xor_b32 v5, 64, v4
    s_lshl_b32 s54, s41, 6
    s_lshl_b32 s49, s53, 5
    s_add_u32 s54, s54, s49
    s_waitcnt lgkmcnt(0)
    s_add_u32 s16, s4, 14958592
    s_addc_u32 s17, s5, 0
    s_mov_b32 s18, 20480
    s_mov_b32 s19, 0x00020000
    s_add_u32 s20, s4, 2637824
    s_addc_u32 s21, s5, 0
    s_mov_b32 s22, 12320768
    s_mov_b32 s23, 0x00020000
    v_add_u32 v18, s54, v15
    v_lshlrev_b32 v18, 5, v18
    buffer_load_dwordx2 v[20:21], v18, s[16:19], 0 offen offset:0
    buffer_load_dwordx2 v[22:23], v18, s[16:19], 0 offen offset:24
    buffer_load_dwordx2 v[24:25], v18, s[16:19], 0 offen offset:512
    buffer_load_dwordx2 v[26:27], v18, s[16:19], 0 offen offset:536
    s_lshl_b32 s55, s54, 7
    v_add_u32 v17, s55, v17
    v_xor_b32 v13, 64, v17
    v_add_u32 v13, 1024, v13
    s_lshl_b32 s49, s53, 11
    s_lshl_b32 s50, s52, 5
    s_add_u32 s49, s49, s50
    v_lshlrev_b32 v19, 3, v14
    v_lshl_add_u32 v19, v15, 6, v19
    v_add_u32 v19, s49, v19
    s_lshl_b32 s49, s53, 8
    v_lshlrev_b32 v18, 3, v15
    v_add_u32 v18, s49, v18
    v_mov_b32 v64, 0
    v_mov_b32 v65, 0
    v_mov_b32 v66, 0
    v_mov_b32 v67, 0
    v_mov_b32 v68, 0
    v_mov_b32 v69, 0
    v_mov_b32 v70, 0
    v_mov_b32 v71, 0
    v_mov_b32 v72, 0
    v_mov_b32 v73, 0
    v_mov_b32 v74, 0
    v_mov_b32 v75, 0
    v_mov_b32 v76, 0
    v_mov_b32 v77, 0
    v_mov_b32 v78, 0
    v_mov_b32 v79, 0
    v_mov_b32 v80, 0
    v_mov_b32 v81, 0
    v_mov_b32 v82, 0
    v_mov_b32 v83, 0
    v_mov_b32 v84, 0
    v_mov_b32 v85, 0
    v_mov_b32 v86, 0
    v_mov_b32 v87, 0
    v_mov_b32 v88, 0
    v_mov_b32 v89, 0
    v_mov_b32 v90, 0
    v_mov_b32 v91, 0
    v_mov_b32 v92, 0
    v_mov_b32 v93, 0
    v_mov_b32 v94, 0
    v_mov_b32 v95, 0
    v_mov_b32 v96, 0
    v_mov_b32 v97, 0
    v_mov_b32 v98, 0
    v_mov_b32 v99, 0
    v_mov_b32 v100, 0
    v_mov_b32 v101, 0
    v_mov_b32 v102, 0
    v_mov_b32 v103, 0
    v_mov_b32 v104, 0
    v_mov_b32 v105, 0
    v_mov_b32 v106, 0
    v_mov_b32 v107, 0
    v_mov_b32 v108, 0
    v_mov_b32 v109, 0
    v_mov_b32 v110, 0
    v_mov_b32 v111, 0
    v_mov_b32 v112, 0
    v_mov_b32 v113, 0
    v_mov_b32 v114, 0
    v_mov_b32 v115, 0
    v_mov_b32 v116, 0
    v_mov_b32 v117, 0
    v_mov_b32 v118, 0
    v_mov_b32 v119, 0
    v_mov_b32 v120, 0
    v_mov_b32 v121, 0
    v_mov_b32 v122, 0
    v_mov_b32 v123, 0
    v_mov_b32 v124, 0
    v_mov_b32 v125, 0
    v_mov_b32 v126, 0
    v_mov_b32 v127, 0
    s_mov_b32 s43, 0
    v_add_u32 v8, s43, v2
    v_add_u32 v10, s43, v4
    v_add_u32 v9, s43, v3
    v_add_u32 v11, s43, v5
    s_barrier
    ds_read_b128 v[128:131], v8 offset:0
    ds_read_b128 v[144:147], v10 offset:0
    ds_read_b128 v[148:151], v10 offset:2048
    ds_read_b128 v[152:155], v10 offset:4096
    ds_read_b128 v[156:159], v10 offset:6144
    ds_read_b128 v[132:135], v8 offset:2048
    ds_read_b128 v[136:139], v8 offset:4096
    ds_read_b128 v[140:143], v8 offset:6144
    s_mov_b32 s51, 0
    s_waitcnt lgkmcnt(0)
k1_loop_bu:
    v_mfma_f32_16x16x32_bf16 v[64:67], v[128:131], v[144:147], v[64:67]
    ds_read_b128 v[160:163], v9 offset:0
    v_mfma_f32_16x16x32_bf16 v[68:71], v[128:131], v[148:151], v[68:71]
    ds_read_b128 v[176:179], v11 offset:0
    v_mfma_f32_16x16x32_bf16 v[72:75], v[128:131], v[152:155], v[72:75]
    ds_read_b128 v[180:183], v11 offset:2048
    v_mfma_f32_16x16x32_bf16 v[76:79], v[128:131], v[156:159], v[76:79]
    ds_read_b128 v[184:187], v11 offset:4096
    v_mfma_f32_16x16x32_bf16 v[80:83], v[132:135], v[144:147], v[80:83]
    ds_read_b128 v[188:191], v11 offset:6144
    v_mfma_f32_16x16x32_bf16 v[84:87], v[132:135], v[148:151], v[84:87]
    ds_read_b128 v[164:167], v9 offset:2048
    v_mfma_f32_16x16x32_bf16 v[88:91], v[132:135], v[152:155], v[88:91]
    ds_read_b128 v[168:171], v9 offset:4096
    v_mfma_f32_16x16x32_bf16 v[92:95], v[132:135], v[156:159], v[92:95]
    ds_read_b128 v[172:175], v9 offset:6144
    v_mfma_f32_16x16x32_bf16 v[96:99], v[136:139], v[144:147], v[96:99]
    v_mfma_f32_16x16x32_bf16 v[100:103], v[136:139], v[148:151], v[100:103]
    v_mfma_f32_16x16x32_bf16 v[104:107], v[136:139], v[152:155], v[104:107]
    v_mfma_f32_16x16x32_bf16 v[108:111], v[136:139], v[156:159], v[108:111]
    v_mfma_f32_16x16x32_bf16 v[112:115], v[140:143], v[144:147], v[112:115]
    v_mfma_f32_16x16x32_bf16 v[116:119], v[140:143], v[148:151], v[116:119]
    v_mfma_f32_16x16x32_bf16 v[120:123], v[140:143], v[152:155], v[120:123]
    v_mfma_f32_16x16x32_bf16 v[124:127], v[140:143], v[156:159], v[124:127]
    s_add_u32 s43, s43, 32768
    s_cmp_eq_u32 s43, 163840
    s_cselect_b32 s43, 0, s43
    s_waitcnt lgkmcnt(0)
    v_mfma_f32_16x16x32_bf16 v[64:67], v[160:163], v[176:179], v[64:67]
    v_add_u32 v8, s43, v2
    v_add_u32 v10, s43, v4
    v_add_u32 v9, s43, v3
    v_add_u32 v11, s43, v5
    s_barrier
    ds_read_b128 v[128:131], v8 offset:0
    v_mfma_f32_16x16x32_bf16 v[68:71], v[160:163], v[180:183], v[68:71]
    ds_read_b128 v[144:147], v10 offset:0
    v_mfma_f32_16x16x32_bf16 v[72:75], v[160:163], v[184:187], v[72:75]
    ds_read_b128 v[148:151], v10 offset:2048
    v_mfma_f32_16x16x32_bf16 v[76:79], v[160:163], v[188:191], v[76:79]
    ds_read_b128 v[152:155], v10 offset:4096
    v_mfma_f32_16x16x32_bf16 v[80:83], v[164:167], v[176:179], v[80:83]
    ds_read_b128 v[156:159], v10 offset:6144
    v_mfma_f32_16x16x32_bf16 v[84:87], v[164:167], v[180:183], v[84:87]
    ds_read_b128 v[132:135], v8 offset:2048
    v_mfma_f32_16x16x32_bf16 v[88:91], v[164:167], v[184:187], v[88:91]
    ds_read_b128 v[136:139], v8 offset:4096
    v_mfma_f32_16x16x32_bf16 v[92:95], v[164:167], v[188:191], v[92:95]
    ds_read_b128 v[140:143], v8 offset:6144
    v_mfma_f32_16x16x32_bf16 v[96:99], v[168:171], v[176:179], v[96:99]
    v_mfma_f32_16x16x32_bf16 v[100:103], v[168:171], v[180:183], v[100:103]
    v_mfma_f32_16x16x32_bf16 v[104:107], v[168:171], v[184:187], v[104:107]
    v_mfma_f32_16x16x32_bf16 v[108:111], v[168:171], v[188:191], v[108:111]
    v_mfma_f32_16x16x32_bf16 v[112:115], v[172:175], v[176:179], v[112:115]
    v_mfma_f32_16x16x32_bf16 v[116:119], v[172:175], v[180:183], v[116:119]
    v_mfma_f32_16x16x32_bf16 v[120:123], v[172:175], v[184:187], v[120:123]
    v_mfma_f32_16x16x32_bf16 v[124:127], v[172:175], v[188:191], v[124:127]
    s_add_u32 s51, s51, 1
    s_cmp_lt_u32 s51, 10
    s_waitcnt lgkmcnt(0)
    s_cbranch_scc1 k1_loop_bu
    s_nop 7
    s_nop 3
    s_waitcnt vmcnt(0)
    v_pk_fma_f32 v[180:181], v[20:21], v[64:65], v[66:67] op_sel:[0,0,0] op_sel_hi:[0,1,1]
    v_pk_fma_f32 v[188:189], v[24:25], v[68:69], v[70:71] op_sel:[0,0,0] op_sel_hi:[0,1,1]
    v_pk_fma_f32 v[182:183], v[20:21], v[72:73], v[74:75] op_sel:[0,0,0] op_sel_hi:[0,1,1] neg_lo:[0,1,1] neg_hi:[0,1,1]
    v_pk_fma_f32 v[190:191], v[24:25], v[76:77], v[78:79] op_sel:[0,0,0] op_sel_hi:[0,1,1] neg_lo:[0,1,1] neg_hi:[0,1,1]
    v_pk_fma_f32 v[180:181], v[20:21], v[72:73], v[180:181] op_sel:[1,0,0] op_sel_hi:[1,1,1] neg_lo:[1,1,0] neg_hi:[1,1,0]
    v_pk_fma_f32 v[188:189], v[24:25], v[76:77], v[188:189] op_sel:[1,0,0] op_sel_hi:[1,1,1] neg_lo:[1,1,0] neg_hi:[1,1,0]
    v_pk_fma_f32 v[182:183], v[20:21], v[64:65], v[182:183] op_sel:[1,0,0] op_sel_hi:[1,1,1]
    v_pk_fma_f32 v[190:191], v[24:25], v[68:69], v[190:191] op_sel:[1,0,0] op_sel_hi:[1,1,1]
    v_pk_fma_f32 v[176:177], v[20:21], v[180:181], v[80:81] op_sel:[0,0,0] op_sel_hi:[0,1,1]
    v_pk_fma_f32 v[184:185], v[24:25], v[188:189], v[84:85] op_sel:[0,0,0] op_sel_hi:[0,1,1]
    v_pk_fma_f32 v[178:179], v[20:21], v[182:183], v[88:89] op_sel:[0,0,0] op_sel_hi:[0,1,1] neg_lo:[0,0,1] neg_hi:[0,0,1]
    v_pk_fma_f32 v[186:187], v[24:25], v[190:191], v[92:93] op_sel:[0,0,0] op_sel_hi:[0,1,1] neg_lo:[0,0,1] neg_hi:[0,0,1]
    v_pk_fma_f32 v[176:177], v[20:21], v[182:183], v[176:177] op_sel:[1,0,0] op_sel_hi:[1,1,1] neg_lo:[1,0,0] neg_hi:[1,0,0]
    v_pk_fma_f32 v[184:185], v[24:25], v[190:191], v[184:185] op_sel:[1,0,0] op_sel_hi:[1,1,1] neg_lo:[1,0,0] neg_hi:[1,0,0]
    v_pk_fma_f32 v[178:179], v[20:21], v[180:181], v[178:179] op_sel:[1,0,0] op_sel_hi:[1,1,1]
    v_pk_fma_f32 v[186:187], v[24:25], v[188:189], v[186:187] op_sel:[1,0,0] op_sel_hi:[1,1,1]
    v_pk_fma_f32 v[180:181], v[20:21], v[176:177], v[82:83] op_sel:[0,0,0] op_sel_hi:[0,1,1]
    v_pk_fma_f32 v[188:189], v[24:25], v[184:185], v[86:87] op_sel:[0,0,0] op_sel_hi:[0,1,1]
    v_pk_fma_f32 v[182:183], v[20:21], v[178:179], v[90:91] op_sel:[0,0,0] op_sel_hi:[0,1,1] neg_lo:[0,0,1] neg_hi:[0,0,1]
    v_pk_fma_f32 v[190:191], v[24:25], v[186:187], v[94:95] op_sel:[0,0,0] op_sel_hi:[0,1,1] neg_lo:[0,0,1] neg_hi:[0,0,1]
    v_pk_fma_f32 v[180:181], v[20:21], v[178:179], v[180:181] op_sel:[1,0,0] op_sel_hi:[1,1,1] neg_lo:[1,0,0] neg_hi:[1,0,0]
    v_pk_fma_f32 v[188:189], v[24:25], v[186:187], v[188:189] op_sel:[1,0,0] op_sel_hi:[1,1,1] neg_lo:[1,0,0] neg_hi:[1,0,0]
    v_pk_fma_f32 v[182:183], v[20:21], v[176:177], v[182:183] op_sel:[1,0,0] op_sel_hi:[1,1,1]
    v_pk_fma_f32 v[190:191], v[24:25], v[184:185], v[190:191] op_sel:[1,0,0] op_sel_hi:[1,1,1]
    v_pk_fma_f32 v[176:177], v[20:21], v[180:181], v[96:97] op_sel:[0,0,0] op_sel_hi:[0,1,1]
    v_pk_fma_f32 v[184:185], v[24:25], v[188:189], v[100:101] op_sel:[0,0,0] op_sel_hi:[0,1,1]
    v_pk_fma_f32 v[178:179], v[20:21], v[182:183], v[104:105] op_sel:[0,0,0] op_sel_hi:[0,1,1] neg_lo:[0,0,1] neg_hi:[0,0,1]
    v_pk_fma_f32 v[186:187], v[24:25], v[190:191], v[108:109] op_sel:[0,0,0] op_sel_hi:[0,1,1] neg_lo:[0,0,1] neg_hi:[0,0,1]
    v_pk_fma_f32 v[176:177], v[20:21], v[182:183], v[176:177] op_sel:[1,0,0] op_sel_hi:[1,1,1] neg_lo:[1,0,0] neg_hi:[1,0,0]
    v_pk_fma_f32 v[184:185], v[24:25], v[190:191], v[184:185] op_sel:[1,0,0] op_sel_hi:[1,1,1] neg_lo:[1,0,0] neg_hi:[1,0,0]
    v_pk_fma_f32 v[178:179], v[20:21], v[180:181], v[178:179] op_sel:[1,0,0] op_sel_hi:[1,1,1]
    v_pk_fma_f32 v[186:187], v[24:25], v[188:189], v[186:187] op_sel:[1,0,0] op_sel_hi:[1,1,1]
    v_pk_fma_f32 v[180:181], v[20:21], v[176:177], v[98:99] op_sel:[0,0,0] op_sel_hi:[0,1,1]
    v_pk_fma_f32 v[188:189], v[24:25], v[184:185], v[102:103] op_sel:[0,0,0] op_sel_hi:[0,1,1]
    v_pk_fma_f32 v[182:183], v[20:21], v[178:179], v[106:107] op_sel:[0,0,0] op_sel_hi:[0,1,1] neg_lo:[0,0,1] neg_hi:[0,0,1]
    v_pk_fma_f32 v[190:191], v[24:25], v[186:187], v[110:111] op_sel:[0,0,0] op_sel_hi:[0,1,1] neg_lo:[0,0,1] neg_hi:[0,0,1]
    v_pk_fma_f32 v[180:181], v[20:21], v[178:179], v[180:181] op_sel:[1,0,0] op_sel_hi:[1,1,1] neg_lo:[1,0,0] neg_hi:[1,0,0]
    v_pk_fma_f32 v[188:189], v[24:25], v[186:187], v[188:189] op_sel:[1,0,0] op_sel_hi:[1,1,1] neg_lo:[1,0,0] neg_hi:[1,0,0]
    v_pk_fma_f32 v[182:183], v[20:21], v[176:177], v[182:183] op_sel:[1,0,0] op_sel_hi:[1,1,1]
    v_pk_fma_f32 v[190:191], v[24:25], v[184:185], v[190:191] op_sel:[1,0,0] op_sel_hi:[1,1,1]
    v_pk_fma_f32 v[176:177], v[20:21], v[180:181], v[112:113] op_sel:[0,0,0] op_sel_hi:[0,1,1]
    v_pk_fma_f32 v[184:185], v[24:25], v[188:189], v[116:117] op_sel:[0,0,0] op_sel_hi:[0,1,1]
    v_pk_fma_f32 v[178:179], v[20:21], v[182:183], v[120:121] op_sel:[0,0,0] op_sel_hi:[0,1,1] neg_lo:[0,0,1] neg_hi:[0,0,1]
    v_pk_fma_f32 v[186:187], v[24:25], v[190:191], v[124:125] op_sel:[0,0,0] op_sel_hi:[0,1,1] neg_lo:[0,0,1] neg_hi:[0,0,1]
    v_pk_fma_f32 v[176:177], v[20:21], v[182:183], v[176:177] op_sel:[1,0,0] op_sel_hi:[1,1,1] neg_lo:[1,0,0] neg_hi:[1,0,0]
    v_pk_fma_f32 v[184:185], v[24:25], v[190:191], v[184:185] op_sel:[1,0,0] op_sel_hi:[1,1,1] neg_lo:[1,0,0] neg_hi:[1,0,0]
    v_pk_fma_f32 v[178:179], v[20:21], v[180:181], v[178:179] op_sel:[1,0,0] op_sel_hi:[1,1,1]
    v_pk_fma_f32 v[186:187], v[24:25], v[188:189], v[186:187] op_sel:[1,0,0] op_sel_hi:[1,1,1]
    v_pk_fma_f32 v[180:181], v[20:21], v[176:177], v[114:115] op_sel:[0,0,0] op_sel_hi:[0,1,1]
    v_pk_fma_f32 v[188:189], v[24:25], v[184:185], v[118:119] op_sel:[0,0,0] op_sel_hi:[0,1,1]
    v_pk_fma_f32 v[182:183], v[20:21], v[178:179], v[122:123] op_sel:[0,0,0] op_sel_hi:[0,1,1] neg_lo:[0,0,1] neg_hi:[0,0,1]
    v_pk_fma_f32 v[190:191], v[24:25], v[186:187], v[126:127] op_sel:[0,0,0] op_sel_hi:[0,1,1] neg_lo:[0,0,1] neg_hi:[0,0,1]
    v_pk_fma_f32 v[180:181], v[20:21], v[178:179], v[180:181] op_sel:[1,0,0] op_sel_hi:[1,1,1] neg_lo:[1,0,0] neg_hi:[1,0,0]
    v_pk_fma_f32 v[188:189], v[24:25], v[186:187], v[188:189] op_sel:[1,0,0] op_sel_hi:[1,1,1] neg_lo:[1,0,0] neg_hi:[1,0,0]
    v_pk_fma_f32 v[182:183], v[20:21], v[176:177], v[182:183] op_sel:[1,0,0] op_sel_hi:[1,1,1]
    v_pk_fma_f32 v[190:191], v[24:25], v[184:185], v[190:191] op_sel:[1,0,0] op_sel_hi:[1,1,1]
    ds_write_b64 v19, v[180:181] offset:0
    ds_write_b64 v19, v[182:183] offset:4096
    ds_write_b64 v19, v[188:189] offset:1024
    ds_write_b64 v19, v[190:191] offset:5120
    s_waitcnt lgkmcnt(0)
    s_barrier
    ds_read_b64 v[200:201], v19 offset:16384
    ds_read_b64 v[202:203], v19 offset:20480
    ds_read_b64 v[204:205], v19 offset:17408
    ds_read_b64 v[206:207], v19 offset:21504
    v_pk_mul_f32 v[128:129], v[22:23], v[64:65] op_sel:[0,0] op_sel_hi:[0,1]
    v_pk_mul_f32 v[144:145], v[26:27], v[68:69] op_sel:[0,0] op_sel_hi:[0,1]
    v_pk_fma_f32 v[128:129], v[22:23], v[72:73], v[128:129] op_sel:[1,0,0] op_sel_hi:[1,1,1] neg_lo:[1,0,0] neg_hi:[1,0,0]
    v_pk_fma_f32 v[144:145], v[26:27], v[76:77], v[144:145] op_sel:[1,0,0] op_sel_hi:[1,1,1] neg_lo:[1,0,0] neg_hi:[1,0,0]
    v_pk_mul_f32 v[72:73], v[22:23], v[72:73] op_sel:[0,0] op_sel_hi:[0,1] neg_lo:[1,0] neg_hi:[1,0]
    v_pk_mul_f32 v[76:77], v[26:27], v[76:77] op_sel:[0,0] op_sel_hi:[0,1] neg_lo:[1,0] neg_hi:[1,0]
    v_pk_fma_f32 v[72:73], v[22:23], v[64:65], v[72:73] op_sel:[1,0,0] op_sel_hi:[1,1,1] neg_lo:[1,0,0] neg_hi:[1,0,0]
    v_pk_fma_f32 v[76:77], v[26:27], v[68:69], v[76:77] op_sel:[1,0,0] op_sel_hi:[1,1,1] neg_lo:[1,0,0] neg_hi:[1,0,0]
    v_pk_mul_f32 v[130:131], v[22:23], v[66:67] op_sel:[0,0] op_sel_hi:[0,1]
    v_pk_mul_f32 v[146:147], v[26:27], v[70:71] op_sel:[0,0] op_sel_hi:[0,1]
    v_pk_fma_f32 v[130:131], v[22:23], v[74:75], v[130:131] op_sel:[1,0,0] op_sel_hi:[1,1,1] neg_lo:[1,0,0] neg_hi:[1,0,0]
    v_pk_fma_f32 v[146:147], v[26:27], v[78:79], v[146:147] op_sel:[1,0,0] op_sel_hi:[1,1,1] neg_lo:[1,0,0] neg_hi:[1,0,0]
    v_pk_mul_f32 v[74:75], v[22:23], v[74:75] op_sel:[0,0] op_sel_hi:[0,1] neg_lo:[1,0] neg_hi:[1,0]
    v_pk_mul_f32 v[78:79], v[26:27], v[78:79] op_sel:[0,0] op_sel_hi:[0,1] neg_lo:[1,0] neg_hi:[1,0]
    v_pk_fma_f32 v[74:75], v[22:23], v[66:67], v[74:75] op_sel:[1,0,0] op_sel_hi:[1,1,1] neg_lo:[1,0,0] neg_hi:[1,0,0]
    v_pk_fma_f32 v[78:79], v[26:27], v[70:71], v[78:79] op_sel:[1,0,0] op_sel_hi:[1,1,1] neg_lo:[1,0,0] neg_hi:[1,0,0]
    v_pk_mul_f32 v[132:133], v[22:23], v[80:81] op_sel:[0,0] op_sel_hi:[0,1]
    v_pk_mul_f32 v[148:149], v[26:27], v[84:85] op_sel:[0,0] op_sel_hi:[0,1]
    v_pk_fma_f32 v[132:133], v[22:23], v[88:89], v[132:133] op_sel:[1,0,0] op_sel_hi:[1,1,1] neg_lo:[1,0,0] neg_hi:[1,0,0]
    v_pk_fma_f32 v[148:149], v[26:27], v[92:93], v[148:149] op_sel:[1,0,0] op_sel_hi:[1,1,1] neg_lo:[1,0,0] neg_hi:[1,0,0]
    v_pk_mul_f32 v[88:89], v[22:23], v[88:89] op_sel:[0,0] op_sel_hi:[0,1] neg_lo:[1,0] neg_hi:[1,0]
    v_pk_mul_f32 v[92:93], v[26:27], v[92:93] op_sel:[0,0] op_sel_hi:[0,1] neg_lo:[1,0] neg_hi:[1,0]
    v_pk_fma_f32 v[88:89], v[22:23], v[80:81], v[88:89] op_sel:[1,0,0] op_sel_hi:[1,1,1] neg_lo:[1,0,0] neg_hi:[1,0,0]
    v_pk_fma_f32 v[92:93], v[26:27], v[84:85], v[92:93] op_sel:[1,0,0] op_sel_hi:[1,1,1] neg_lo:[1,0,0] neg_hi:[1,0,0]
    v_pk_mul_f32 v[134:135], v[22:23], v[82:83] op_sel:[0,0] op_sel_hi:[0,1]
    v_pk_mul_f32 v[150:151], v[26:27], v[86:87] op_sel:[0,0] op_sel_hi:[0,1]
    v_pk_fma_f32 v[134:135], v[22:23], v[90:91], v[134:135] op_sel:[1,0,0] op_sel_hi:[1,1,1] neg_lo:[1,0,0] neg_hi:[1,0,0]
    v_pk_fma_f32 v[150:151], v[26:27], v[94:95], v[150:151] op_sel:[1,0,0] op_sel_hi:[1,1,1] neg_lo:[1,0,0] neg_hi:[1,0,0]
    v_pk_mul_f32 v[90:91], v[22:23], v[90:91] op_sel:[0,0] op_sel_hi:[0,1] neg_lo:[1,0] neg_hi:[1,0]
    v_pk_mul_f32 v[94:95], v[26:27], v[94:95] op_sel:[0,0] op_sel_hi:[0,1] neg_lo:[1,0] neg_hi:[1,0]
    v_pk_fma_f32 v[90:91], v[22:23], v[82:83], v[90:91] op_sel:[1,0,0] op_sel_hi:[1,1,1] neg_lo:[1,0,0] neg_hi:[1,0,0]
    v_pk_fma_f32 v[94:95], v[26:27], v[86:87], v[94:95] op_sel:[1,0,0] op_sel_hi:[1,1,1] neg_lo:[1,0,0] neg_hi:[1,0,0]
    v_pk_mul_f32 v[136:137], v[22:23], v[96:97] op_sel:[0,0] op_sel_hi:[0,1]
    v_pk_mul_f32 v[152:153], v[26:27], v[100:101] op_sel:[0,0] op_sel_hi:[0,1]
    v_pk_fma_f32 v[136:137], v[22:23], v[104:105], v[136:137] op_sel:[1,0,0] op_sel_hi:[1,1,1] neg_lo:[1,0,0] neg_hi:[1,0,0]
    v_pk_fma_f32 v[152:153], v[26:27], v[108:109], v[152:153] op_sel:[1,0,0] op_sel_hi:[1,1,1] neg_lo:[1,0,0] neg_hi:[1,0,0]
    v_pk_mul_f32 v[104:105], v[22:23], v[104:105] op_sel:[0,0] op_sel_hi:[0,1] neg_lo:[1,0] neg_hi:[1,0]
    v_pk_mul_f32 v[108:109], v[26:27], v[108:109] op_sel:[0,0] op_sel_hi:[0,1] neg_lo:[1,0] neg_hi:[1,0]
    v_pk_fma_f32 v[104:105], v[22:23], v[96:97], v[104:105] op_sel:[1,0,0] op_sel_hi:[1,1,1] neg_lo:[1,0,0] neg_hi:[1,0,0]
    v_pk_fma_f32 v[108:109], v[26:27], v[100:101], v[108:109] op_sel:[1,0,0] op_sel_hi:[1,1,1] neg_lo:[1,0,0] neg_hi:[1,0,0]
    v_pk_mul_f32 v[138:139], v[22:23], v[98:99] op_sel:[0,0] op_sel_hi:[0,1]
    v_pk_mul_f32 v[154:155], v[26:27], v[102:103] op_sel:[0,0] op_sel_hi:[0,1]
    v_pk_fma_f32 v[138:139], v[22:23], v[106:107], v[138:139] op_sel:[1,0,0] op_sel_hi:[1,1,1] neg_lo:[1,0,0] neg_hi:[1,0,0]
    v_pk_fma_f32 v[154:155], v[26:27], v[110:111], v[154:155] op_sel:[1,0,0] op_sel_hi:[1,1,1] neg_lo:[1,0,0] neg_hi:[1,0,0]
    v_pk_mul_f32 v[106:107], v[22:23], v[106:107] op_sel:[0,0] op_sel_hi:[0,1] neg_lo:[1,0] neg_hi:[1,0]
    v_pk_mul_f32 v[110:111], v[26:27], v[110:111] op_sel:[0,0] op_sel_hi:[0,1] neg_lo:[1,0] neg_hi:[1,0]
    v_pk_fma_f32 v[106:107], v[22:23], v[98:99], v[106:107] op_sel:[1,0,0] op_sel_hi:[1,1,1] neg_lo:[1,0,0] neg_hi:[1,0,0]
    v_pk_fma_f32 v[110:111], v[26:27], v[102:103], v[110:111] op_sel:[1,0,0] op_sel_hi:[1,1,1] neg_lo:[1,0,0] neg_hi:[1,0,0]
    v_pk_mul_f32 v[140:141], v[22:23], v[112:113] op_sel:[0,0] op_sel_hi:[0,1]
    v_pk_mul_f32 v[156:157], v[26:27], v[116:117] op_sel:[0,0] op_sel_hi:[0,1]
    v_pk_fma_f32 v[140:141], v[22:23], v[120:121], v[140:141] op_sel:[1,0,0] op_sel_hi:[1,1,1] neg_lo:[1,0,0] neg_hi:[1,0,0]
    v_pk_fma_f32 v[156:157], v[26:27], v[124:125], v[156:157] op_sel:[1,0,0] op_sel_hi:[1,1,1] neg_lo:[1,0,0] neg_hi:[1,0,0]
    v_pk_mul_f32 v[120:121], v[22:23], v[120:121] op_sel:[0,0] op_sel_hi:[0,1] neg_lo:[1,0] neg_hi:[1,0]
    v_pk_mul_f32 v[124:125], v[26:27], v[124:125] op_sel:[0,0] op_sel_hi:[0,1] neg_lo:[1,0] neg_hi:[1,0]
    v_pk_fma_f32 v[120:121], v[22:23], v[112:113], v[120:121] op_sel:[1,0,0] op_sel_hi:[1,1,1] neg_lo:[1,0,0] neg_hi:[1,0,0]
    v_pk_fma_f32 v[124:125], v[26:27], v[116:117], v[124:125] op_sel:[1,0,0] op_sel_hi:[1,1,1] neg_lo:[1,0,0] neg_hi:[1,0,0]
    v_pk_mul_f32 v[142:143], v[22:23], v[114:115] op_sel:[0,0] op_sel_hi:[0,1]
    v_pk_mul_f32 v[158:159], v[26:27], v[118:119] op_sel:[0,0] op_sel_hi:[0,1]
    v_pk_fma_f32 v[142:143], v[22:23], v[122:123], v[142:143] op_sel:[1,0,0] op_sel_hi:[1,1,1] neg_lo:[1,0,0] neg_hi:[1,0,0]
    v_pk_fma_f32 v[158:159], v[26:27], v[126:127], v[158:159] op_sel:[1,0,0] op_sel_hi:[1,1,1] neg_lo:[1,0,0] neg_hi:[1,0,0]
    v_pk_mul_f32 v[122:123], v[22:23], v[122:123] op_sel:[0,0] op_sel_hi:[0,1] neg_lo:[1,0] neg_hi:[1,0]
    v_pk_mul_f32 v[126:127], v[26:27], v[126:127] op_sel:[0,0] op_sel_hi:[0,1] neg_lo:[1,0] neg_hi:[1,0]
    v_pk_fma_f32 v[122:123], v[22:23], v[114:115], v[122:123] op_sel:[1,0,0] op_sel_hi:[1,1,1] neg_lo:[1,0,0] neg_hi:[1,0,0]
    v_pk_fma_f32 v[126:127], v[26:27], v[118:119], v[126:127] op_sel:[1,0,0] op_sel_hi:[1,1,1] neg_lo:[1,0,0] neg_hi:[1,0,0]
    s_waitcnt lgkmcnt(0)
    s_barrier
    ds_read_b64 v[176:177], v19 offset:8192
    ds_read_b64 v[178:179], v19 offset:12288
    ds_read_b64 v[180:181], v18 offset:24576
    ds_read_b64 v[184:185], v19 offset:9216
    ds_read_b64 v[186:187], v19 offset:13312
    ds_read_b64 v[188:189], v18 offset:24704
    s_waitcnt lgkmcnt(0)
    v_pk_fma_f32 v[176:177], v[180:181], v[200:201], v[176:177] op_sel:[0,0,0] op_sel_hi:[0,1,1]
    v_pk_fma_f32 v[184:185], v[188:189], v[204:205], v[184:185] op_sel:[0,0,0] op_sel_hi:[0,1,1]
    v_pk_fma_f32 v[178:179], v[180:181], v[202:203], v[178:179] op_sel:[0,0,0] op_sel_hi:[0,1,1]
    v_pk_fma_f32 v[186:187], v[188:189], v[206:207], v[186:187] op_sel:[0,0,0] op_sel_hi:[0,1,1]
    v_pk_fma_f32 v[176:177], v[180:181], v[202:203], v[176:177] op_sel:[1,0,0] op_sel_hi:[1,1,1] neg_lo:[1,0,0] neg_hi:[1,0,0]
    v_pk_fma_f32 v[184:185], v[188:189], v[206:207], v[184:185] op_sel:[1,0,0] op_sel_hi:[1,1,1] neg_lo:[1,0,0] neg_hi:[1,0,0]
    v_pk_fma_f32 v[178:179], v[180:181], v[200:201], v[178:179] op_sel:[1,0,0] op_sel_hi:[1,1,1]
    v_pk_fma_f32 v[186:187], v[188:189], v[204:205], v[186:187] op_sel:[1,0,0] op_sel_hi:[1,1,1]
    v_pk_fma_f32 v[128:129], v[20:21], v[176:177], v[128:129] op_sel:[0,0,0] op_sel_hi:[0,1,1]
    v_pk_fma_f32 v[72:73], v[20:21], v[178:179], v[72:73] op_sel:[0,0,0] op_sel_hi:[0,1,1]
    v_pk_fma_f32 v[128:129], v[20:21], v[178:179], v[128:129] op_sel:[1,0,0] op_sel_hi:[1,1,1] neg_lo:[1,0,0] neg_hi:[1,0,0]
    v_pk_fma_f32 v[72:73], v[20:21], v[176:177], v[72:73] op_sel:[1,0,0] op_sel_hi:[1,1,1]
    v_pk_fma_f32 v[130:131], v[20:21], v[128:129], v[130:131] op_sel:[0,0,0] op_sel_hi:[0,1,1]
    v_pk_fma_f32 v[74:75], v[20:21], v[72:73], v[74:75] op_sel:[0,0,0] op_sel_hi:[0,1,1]
    v_pk_fma_f32 v[130:131], v[20:21], v[72:73], v[130:131] op_sel:[1,0,0] op_sel_hi:[1,1,1] neg_lo:[1,0,0] neg_hi:[1,0,0]
    v_pk_fma_f32 v[74:75], v[20:21], v[128:129], v[74:75] op_sel:[1,0,0] op_sel_hi:[1,1,1]
    v_pk_fma_f32 v[132:133], v[20:21], v[130:131], v[132:133] op_sel:[0,0,0] op_sel_hi:[0,1,1]
    v_pk_fma_f32 v[88:89], v[20:21], v[74:75], v[88:89] op_sel:[0,0,0] op_sel_hi:[0,1,1]
    v_pk_fma_f32 v[132:133], v[20:21], v[74:75], v[132:133] op_sel:[1,0,0] op_sel_hi:[1,1,1] neg_lo:[1,0,0] neg_hi:[1,0,0]
    v_pk_fma_f32 v[88:89], v[20:21], v[130:131], v[88:89] op_sel:[1,0,0] op_sel_hi:[1,1,1]
    v_pk_fma_f32 v[134:135], v[20:21], v[132:133], v[134:135] op_sel:[0,0,0] op_sel_hi:[0,1,1]
    v_pk_fma_f32 v[90:91], v[20:21], v[88:89], v[90:91] op_sel:[0,0,0] op_sel_hi:[0,1,1]
    v_pk_fma_f32 v[134:135], v[20:21], v[88:89], v[134:135] op_sel:[1,0,0] op_sel_hi:[1,1,1] neg_lo:[1,0,0] neg_hi:[1,0,0]
    v_pk_fma_f32 v[90:91], v[20:21], v[132:133], v[90:91] op_sel:[1,0,0] op_sel_hi:[1,1,1]
    v_pk_fma_f32 v[136:137], v[20:21], v[134:135], v[136:137] op_sel:[0,0,0] op_sel_hi:[0,1,1]
    v_pk_fma_f32 v[104:105], v[20:21], v[90:91], v[104:105] op_sel:[0,0,0] op_sel_hi:[0,1,1]
    v_pk_fma_f32 v[136:137], v[20:21], v[90:91], v[136:137] op_sel:[1,0,0] op_sel_hi:[1,1,1] neg_lo:[1,0,0] neg_hi:[1,0,0]
    v_pk_fma_f32 v[104:105], v[20:21], v[134:135], v[104:105] op_sel:[1,0,0] op_sel_hi:[1,1,1]
    v_pk_fma_f32 v[138:139], v[20:21], v[136:137], v[138:139] op_sel:[0,0,0] op_sel_hi:[0,1,1]
    v_pk_fma_f32 v[106:107], v[20:21], v[104:105], v[106:107] op_sel:[0,0,0] op_sel_hi:[0,1,1]
    v_pk_fma_f32 v[138:139], v[20:21], v[104:105], v[138:139] op_sel:[1,0,0] op_sel_hi:[1,1,1] neg_lo:[1,0,0] neg_hi:[1,0,0]
    v_pk_fma_f32 v[106:107], v[20:21], v[136:137], v[106:107] op_sel:[1,0,0] op_sel_hi:[1,1,1]
    v_pk_fma_f32 v[140:141], v[20:21], v[138:139], v[140:141] op_sel:[0,0,0] op_sel_hi:[0,1,1]
    v_pk_fma_f32 v[120:121], v[20:21], v[106:107], v[120:121] op_sel:[0,0,0] op_sel_hi:[0,1,1]
    v_pk_fma_f32 v[140:141], v[20:21], v[106:107], v[140:141] op_sel:[1,0,0] op_sel_hi:[1,1,1] neg_lo:[1,0,0] neg_hi:[1,0,0]
    v_pk_fma_f32 v[120:121], v[20:21], v[138:139], v[120:121] op_sel:[1,0,0] op_sel_hi:[1,1,1]
    v_pk_fma_f32 v[142:143], v[20:21], v[140:141], v[142:143] op_sel:[0,0,0] op_sel_hi:[0,1,1]
    v_pk_fma_f32 v[122:123], v[20:21], v[120:121], v[122:123] op_sel:[0,0,0] op_sel_hi:[0,1,1]
    v_pk_fma_f32 v[142:143], v[20:21], v[120:121], v[142:143] op_sel:[1,0,0] op_sel_hi:[1,1,1] neg_lo:[1,0,0] neg_hi:[1,0,0]
    v_pk_fma_f32 v[122:123], v[20:21], v[140:141], v[122:123] op_sel:[1,0,0] op_sel_hi:[1,1,1]
    v_cvt_pk_bf16_f32 v32, v128, v130
    v_cvt_pk_bf16_f32 v33, v132, v134
    v_cvt_pk_bf16_f32 v34, v136, v138
    v_cvt_pk_bf16_f32 v35, v140, v142
    v_cvt_pk_bf16_f32 v36, v129, v131
    v_cvt_pk_bf16_f32 v37, v133, v135
    v_cvt_pk_bf16_f32 v38, v137, v139
    v_cvt_pk_bf16_f32 v39, v141, v143
    v_mov_b32 v208, v36
    v_mov_b32 v209, v37
    v_mov_b32 v210, v38
    v_mov_b32 v211, v39
    v_mov_b32_dpp v36, v32 row_ror:8 row_mask:0xf bank_mask:0x3
    v_mov_b32_dpp v37, v33 row_ror:8 row_mask:0xf bank_mask:0x3
    v_mov_b32_dpp v38, v34 row_ror:8 row_mask:0xf bank_mask:0x3
    v_mov_b32_dpp v39, v35 row_ror:8 row_mask:0xf bank_mask:0x3
    v_mov_b32_dpp v32, v208 row_ror:8 row_mask:0xf bank_mask:0xc
    v_mov_b32_dpp v33, v209 row_ror:8 row_mask:0xf bank_mask:0xc
    v_mov_b32_dpp v34, v210 row_ror:8 row_mask:0xf bank_mask:0xc
    v_mov_b32_dpp v35, v211 row_ror:8 row_mask:0xf bank_mask:0xc
    s_mov_b32 s49, 0
    buffer_store_dwordx4 v[32:35], v17, s[20:23], s49 offen sc1
    buffer_store_dwordx4 v[36:39], v13, s[20:23], s49 offen sc1
    v_cvt_pk_bf16_f32 v40, v72, v74
    v_cvt_pk_bf16_f32 v41, v88, v90
    v_cvt_pk_bf16_f32 v42, v104, v106
    v_cvt_pk_bf16_f32 v43, v120, v122
    v_cvt_pk_bf16_f32 v44, v73, v75
    v_cvt_pk_bf16_f32 v45, v89, v91
    v_cvt_pk_bf16_f32 v46, v105, v107
    v_cvt_pk_bf16_f32 v47, v121, v123
    v_mov_b32 v212, v44
    v_mov_b32 v213, v45
    v_mov_b32 v214, v46
    v_mov_b32 v215, v47
    v_mov_b32_dpp v44, v40 row_ror:8 row_mask:0xf bank_mask:0x3
    v_mov_b32_dpp v45, v41 row_ror:8 row_mask:0xf bank_mask:0x3
    v_mov_b32_dpp v46, v42 row_ror:8 row_mask:0xf bank_mask:0x3
    v_mov_b32_dpp v47, v43 row_ror:8 row_mask:0xf bank_mask:0x3
    v_mov_b32_dpp v40, v212 row_ror:8 row_mask:0xf bank_mask:0xc
    v_mov_b32_dpp v41, v213 row_ror:8 row_mask:0xf bank_mask:0xc
    v_mov_b32_dpp v42, v214 row_ror:8 row_mask:0xf bank_mask:0xc
    v_mov_b32_dpp v43, v215 row_ror:8 row_mask:0xf bank_mask:0xc
    s_mov_b32 s49, 81920
    buffer_store_dwordx4 v[40:43], v17, s[20:23], s49 offen sc1
    buffer_store_dwordx4 v[44:47], v13, s[20:23], s49 offen sc1
    v_pk_fma_f32 v[144:145], v[24:25], v[184:185], v[144:145] op_sel:[0,0,0] op_sel_hi:[0,1,1]
    v_pk_fma_f32 v[76:77], v[24:25], v[186:187], v[76:77] op_sel:[0,0,0] op_sel_hi:[0,1,1]
    v_pk_fma_f32 v[144:145], v[24:25], v[186:187], v[144:145] op_sel:[1,0,0] op_sel_hi:[1,1,1] neg_lo:[1,0,0] neg_hi:[1,0,0]
    v_pk_fma_f32 v[76:77], v[24:25], v[184:185], v[76:77] op_sel:[1,0,0] op_sel_hi:[1,1,1]
    v_pk_fma_f32 v[146:147], v[24:25], v[144:145], v[146:147] op_sel:[0,0,0] op_sel_hi:[0,1,1]
    v_pk_fma_f32 v[78:79], v[24:25], v[76:77], v[78:79] op_sel:[0,0,0] op_sel_hi:[0,1,1]
    v_pk_fma_f32 v[146:147], v[24:25], v[76:77], v[146:147] op_sel:[1,0,0] op_sel_hi:[1,1,1] neg_lo:[1,0,0] neg_hi:[1,0,0]
    v_pk_fma_f32 v[78:79], v[24:25], v[144:145], v[78:79] op_sel:[1,0,0] op_sel_hi:[1,1,1]
    v_pk_fma_f32 v[148:149], v[24:25], v[146:147], v[148:149] op_sel:[0,0,0] op_sel_hi:[0,1,1]
    v_pk_fma_f32 v[92:93], v[24:25], v[78:79], v[92:93] op_sel:[0,0,0] op_sel_hi:[0,1,1]
    v_pk_fma_f32 v[148:149], v[24:25], v[78:79], v[148:149] op_sel:[1,0,0] op_sel_hi:[1,1,1] neg_lo:[1,0,0] neg_hi:[1,0,0]
    v_pk_fma_f32 v[92:93], v[24:25], v[146:147], v[92:93] op_sel:[1,0,0] op_sel_hi:[1,1,1]
    v_pk_fma_f32 v[150:151], v[24:25], v[148:149], v[150:151] op_sel:[0,0,0] op_sel_hi:[0,1,1]
    v_pk_fma_f32 v[94:95], v[24:25], v[92:93], v[94:95] op_sel:[0,0,0] op_sel_hi:[0,1,1]
    v_pk_fma_f32 v[150:151], v[24:25], v[92:93], v[150:151] op_sel:[1,0,0] op_sel_hi:[1,1,1] neg_lo:[1,0,0] neg_hi:[1,0,0]
    v_pk_fma_f32 v[94:95], v[24:25], v[148:149], v[94:95] op_sel:[1,0,0] op_sel_hi:[1,1,1]
    v_pk_fma_f32 v[152:153], v[24:25], v[150:151], v[152:153] op_sel:[0,0,0] op_sel_hi:[0,1,1]
    v_pk_fma_f32 v[108:109], v[24:25], v[94:95], v[108:109] op_sel:[0,0,0] op_sel_hi:[0,1,1]
    v_pk_fma_f32 v[152:153], v[24:25], v[94:95], v[152:153] op_sel:[1,0,0] op_sel_hi:[1,1,1] neg_lo:[1,0,0] neg_hi:[1,0,0]
    v_pk_fma_f32 v[108:109], v[24:25], v[150:151], v[108:109] op_sel:[1,0,0] op_sel_hi:[1,1,1]
    v_pk_fma_f32 v[154:155], v[24:25], v[152:153], v[154:155] op_sel:[0,0,0] op_sel_hi:[0,1,1]
    v_pk_fma_f32 v[110:111], v[24:25], v[108:109], v[110:111] op_sel:[0,0,0] op_sel_hi:[0,1,1]
    v_pk_fma_f32 v[154:155], v[24:25], v[108:109], v[154:155] op_sel:[1,0,0] op_sel_hi:[1,1,1] neg_lo:[1,0,0] neg_hi:[1,0,0]
    v_pk_fma_f32 v[110:111], v[24:25], v[152:153], v[110:111] op_sel:[1,0,0] op_sel_hi:[1,1,1]
    v_pk_fma_f32 v[156:157], v[24:25], v[154:155], v[156:157] op_sel:[0,0,0] op_sel_hi:[0,1,1]
    v_pk_fma_f32 v[124:125], v[24:25], v[110:111], v[124:125] op_sel:[0,0,0] op_sel_hi:[0,1,1]
    v_pk_fma_f32 v[156:157], v[24:25], v[110:111], v[156:157] op_sel:[1,0,0] op_sel_hi:[1,1,1] neg_lo:[1,0,0] neg_hi:[1,0,0]
    v_pk_fma_f32 v[124:125], v[24:25], v[154:155], v[124:125] op_sel:[1,0,0] op_sel_hi:[1,1,1]
    v_pk_fma_f32 v[158:159], v[24:25], v[156:157], v[158:159] op_sel:[0,0,0] op_sel_hi:[0,1,1]
    v_pk_fma_f32 v[126:127], v[24:25], v[124:125], v[126:127] op_sel:[0,0,0] op_sel_hi:[0,1,1]
    v_pk_fma_f32 v[158:159], v[24:25], v[124:125], v[158:159] op_sel:[1,0,0] op_sel_hi:[1,1,1] neg_lo:[1,0,0] neg_hi:[1,0,0]
    v_pk_fma_f32 v[126:127], v[24:25], v[156:157], v[126:127] op_sel:[1,0,0] op_sel_hi:[1,1,1]
    v_cvt_pk_bf16_f32 v48, v144, v146
    v_cvt_pk_bf16_f32 v49, v148, v150
    v_cvt_pk_bf16_f32 v50, v152, v154
    v_cvt_pk_bf16_f32 v51, v156, v158
    v_cvt_pk_bf16_f32 v52, v145, v147
    v_cvt_pk_bf16_f32 v53, v149, v151
    v_cvt_pk_bf16_f32 v54, v153, v155
    v_cvt_pk_bf16_f32 v55, v157, v159
    v_mov_b32 v208, v52
    v_mov_b32 v209, v53
    v_mov_b32 v210, v54
    v_mov_b32 v211, v55
    v_mov_b32_dpp v52, v48 row_ror:8 row_mask:0xf bank_mask:0x3
    v_mov_b32_dpp v53, v49 row_ror:8 row_mask:0xf bank_mask:0x3
    v_mov_b32_dpp v54, v50 row_ror:8 row_mask:0xf bank_mask:0x3
    v_mov_b32_dpp v55, v51 row_ror:8 row_mask:0xf bank_mask:0x3
    v_mov_b32_dpp v48, v208 row_ror:8 row_mask:0xf bank_mask:0xc
    v_mov_b32_dpp v49, v209 row_ror:8 row_mask:0xf bank_mask:0xc
    v_mov_b32_dpp v50, v210 row_ror:8 row_mask:0xf bank_mask:0xc
    v_mov_b32_dpp v51, v211 row_ror:8 row_mask:0xf bank_mask:0xc
    s_mov_b32 s49, 2048
    buffer_store_dwordx4 v[48:51], v17, s[20:23], s49 offen sc1
    buffer_store_dwordx4 v[52:55], v13, s[20:23], s49 offen sc1
    v_cvt_pk_bf16_f32 v56, v76, v78
    v_cvt_pk_bf16_f32 v57, v92, v94
    v_cvt_pk_bf16_f32 v58, v108, v110
    v_cvt_pk_bf16_f32 v59, v124, v126
    v_cvt_pk_bf16_f32 v60, v77, v79
    v_cvt_pk_bf16_f32 v61, v93, v95
    v_cvt_pk_bf16_f32 v62, v109, v111
    v_cvt_pk_bf16_f32 v63, v125, v127
    v_mov_b32 v212, v60
    v_mov_b32 v213, v61
    v_mov_b32 v214, v62
    v_mov_b32 v215, v63
    v_mov_b32_dpp v60, v56 row_ror:8 row_mask:0xf bank_mask:0x3
    v_mov_b32_dpp v61, v57 row_ror:8 row_mask:0xf bank_mask:0x3
    v_mov_b32_dpp v62, v58 row_ror:8 row_mask:0xf bank_mask:0x3
    v_mov_b32_dpp v63, v59 row_ror:8 row_mask:0xf bank_mask:0x3
    v_mov_b32_dpp v56, v212 row_ror:8 row_mask:0xf bank_mask:0xc
    v_mov_b32_dpp v57, v213 row_ror:8 row_mask:0xf bank_mask:0xc
    v_mov_b32_dpp v58, v214 row_ror:8 row_mask:0xf bank_mask:0xc
    v_mov_b32_dpp v59, v215 row_ror:8 row_mask:0xf bank_mask:0xc
    s_mov_b32 s49, 83968
    buffer_store_dwordx4 v[56:59], v17, s[20:23], s49 offen sc1
    buffer_store_dwordx4 v[60:63], v13, s[20:23], s49 offen sc1
    s_endpgm
k1_ffn:
    v_bfe_u32 v18, v1, 2, 2
    v_and_b32 v19, 3, v1
    v_lshl_add_u32 v20, v14, 3, v18
    v_mul_u32_u24 v20, 576, v20
    v_lshl_add_u32 v20, v19, 3, v20
    v_and_b32 v21, 1, v14
    s_mul_i32 s49, s53, 9
    s_add_u32 s49, s49, 0
    s_and_b32 s50, s49, 1
    s_lshr_b32 s49, s49, 1
    s_lshl_b32 s49, s49, 6
    s_add_u32 s49, s49, 16384
    v_xor_b32 v22, s50, v21
    v_lshl_add_u32 v22, v22, 5, v20
    v_add_u32 v4, s49, v22
    s_mul_i32 s49, s53, 9
    s_add_u32 s49, s49, 1
    s_and_b32 s50, s49, 1
    s_lshr_b32 s49, s49, 1
    s_lshl_b32 s49, s49, 6
    s_add_u32 s49, s49, 16384
    v_xor_b32 v22, s50, v21
    v_lshl_add_u32 v22, v22, 5, v20
    v_add_u32 v5, s49, v22
    s_sub_u32 s54, s41, 10
    s_mul_i32 s54, s54, 288
    s_mul_i32 s49, s53, 144
    s_add_u32 s54, s54, s49
    s_add_u32 s55, s54, 1280
    s_lshl_b32 s55, s55, 7
    v_add_u32 v17, s55, v17
    v_xor_b32 v13, 64, v17
    v_add_u32 v13, 1024, v13
    s_waitcnt lgkmcnt(0)
    s_add_u32 s20, s4, 2637824
    s_addc_u32 s21, s5, 0
    s_mov_b32 s22, 12320768
    s_mov_b32 s23, 0x00020000
    v_mov_b32 v32, 0
    v_mov_b32 v33, 0
    v_mov_b32 v34, 0
    v_mov_b32 v35, 0
    v_mov_b32 v36, 0
    v_mov_b32 v37, 0
    v_mov_b32 v38, 0
    v_mov_b32 v39, 0
    v_mov_b32 v40, 0
    v_mov_b32 v41, 0
    v_mov_b32 v42, 0
    v_mov_b32 v43, 0
    v_mov_b32 v44, 0
    v_mov_b32 v45, 0
    v_mov_b32 v46, 0
    v_mov_b32 v47, 0
    v_mov_b32 v48, 0
    v_mov_b32 v49, 0
    v_mov_b32 v50, 0
    v_mov_b32 v51, 0
    v_mov_b32 v52, 0
    v_mov_b32 v53, 0
    v_mov_b32 v54, 0
    v_mov_b32 v55, 0
    v_mov_b32 v56, 0
    v_mov_b32 v57, 0
    v_mov_b32 v58, 0
    v_mov_b32 v59, 0
    v_mov_b32 v60, 0
    v_mov_b32 v61, 0
    v_mov_b32 v62, 0
    v_mov_b32 v63, 0
    v_mov_b32 v64, 0
    v_mov_b32 v65, 0
    v_mov_b32 v66, 0
    v_mov_b32 v67, 0
    v_mov_b32 v68, 0
    v_mov_b32 v69, 0
    v_mov_b32 v70, 0
    v_mov_b32 v71, 0
    v_mov_b32 v72, 0
    v_mov_b32 v73, 0
    v_mov_b32 v74, 0
    v_mov_b32 v75, 0
    v_mov_b32 v76, 0
    v_mov_b32 v77, 0
    v_mov_b32 v78, 0
    v_mov_b32 v79, 0
    v_mov_b32 v80, 0
    v_mov_b32 v81, 0
    v_mov_b32 v82, 0
    v_mov_b32 v83, 0
    v_mov_b32 v84, 0
    v_mov_b32 v85, 0
    v_mov_b32 v86, 0
    v_mov_b32 v87, 0
    v_mov_b32 v88, 0
    v_mov_b32 v89, 0
    v_mov_b32 v90, 0
    v_mov_b32 v91, 0
    v_mov_b32 v92, 0
    v_mov_b32 v93, 0
    v_mov_b32 v94, 0
    v_mov_b32 v95, 0
    v_mov_b32 v96, 0
    v_mov_b32 v97, 0
    v_mov_b32 v98, 0
    v_mov_b32 v99, 0
    v_mov_b32 v100, 0
    v_mov_b32 v101, 0
    v_mov_b32 v102, 0
    v_mov_b32 v103, 0
    v_mov_b32 v104, 0
    v_mov_b32 v105, 0
    v_mov_b32 v106, 0
    v_mov_b32 v107, 0
    v_mov_b32 v108, 0
    v_mov_b32 v109, 0
    v_mov_b32 v110, 0
    v_mov_b32 v111, 0
    v_mov_b32 v112, 0
    v_mov_b32 v113, 0
    v_mov_b32 v114, 0
    v_mov_b32 v115, 0
    v_mov_b32 v116, 0
    v_mov_b32 v117, 0
    v_mov_b32 v118, 0
    v_mov_b32 v119, 0
    v_mov_b32 v120, 0
    v_mov_b32 v121, 0
    v_mov_b32 v122, 0
    v_mov_b32 v123, 0
    v_mov_b32 v124, 0
    v_mov_b32 v125, 0
    v_mov_b32 v126, 0
    v_mov_b32 v127, 0
    v_mov_b32 v128, 0
    v_mov_b32 v129, 0
    v_mov_b32 v130, 0
    v_mov_b32 v131, 0
    v_mov_b32 v132, 0
    v_mov_b32 v133, 0
    v_mov_b32 v134, 0
    v_mov_b32 v135, 0
    v_mov_b32 v136, 0
    v_mov_b32 v137, 0
    v_mov_b32 v138, 0
    v_mov_b32 v139, 0
    v_mov_b32 v140, 0
    v_mov_b32 v141, 0
    v_mov_b32 v142, 0
    v_mov_b32 v143, 0
    v_mov_b32 v144, 0
    v_mov_b32 v145, 0
    v_mov_b32 v146, 0
    v_mov_b32 v147, 0
    v_mov_b32 v148, 0
    v_mov_b32 v149, 0
    v_mov_b32 v150, 0
    v_mov_b32 v151, 0
    v_mov_b32 v152, 0
    v_mov_b32 v153, 0
    v_mov_b32 v154, 0
    v_mov_b32 v155, 0
    v_mov_b32 v156, 0
    v_mov_b32 v157, 0
    v_mov_b32 v158, 0
    v_mov_b32 v159, 0
    v_mov_b32 v160, 0
    v_mov_b32 v161, 0
    v_mov_b32 v162, 0
    v_mov_b32 v163, 0
    v_mov_b32 v164, 0
    v_mov_b32 v165, 0
    v_mov_b32 v166, 0
    v_mov_b32 v167, 0
    v_mov_b32 v168, 0
    v_mov_b32 v169, 0
    v_mov_b32 v170, 0
    v_mov_b32 v171, 0
    v_mov_b32 v172, 0
    v_mov_b32 v173, 0
    v_mov_b32 v174, 0
    v_mov_b32 v175, 0
    s_mov_b32 s43, 0
    v_add_u32 v8, s43, v2
    v_add_u32 v10, s43, v4
    v_add_u32 v9, s43, v3
    v_add_u32 v11, s43, v5
    s_barrier
    ds_read_b128 v[176:179], v8 offset:0
    ds_read_b128 v[180:183], v8 offset:2048
    ds_read_b128 v[184:187], v8 offset:4096
    ds_read_b128 v[188:191], v8 offset:6144
    ds_read_b64_tr_b16 v[208:209], v10 offset:0
    ds_read_b64_tr_b16 v[210:211], v10 offset:2304
    ds_read_b64_tr_b16 v[212:213], v11 offset:0
    ds_read_b64_tr_b16 v[214:215], v11 offset:2304
    ds_read_b64_tr_b16 v[216:217], v10 offset:64
    ds_read_b64_tr_b16 v[218:219], v10 offset:2368
    ds_read_b64_tr_b16 v[220:221], v11 offset:64
    ds_read_b64_tr_b16 v[222:223], v11 offset:2368
    ds_read_b64_tr_b16 v[224:225], v10 offset:128
    ds_read_b64_tr_b16 v[226:227], v10 offset:2432
    ds_read_b64_tr_b16 v[228:229], v11 offset:128
    ds_read_b64_tr_b16 v[230:231], v11 offset:2432
    ds_read_b64_tr_b16 v[232:233], v10 offset:192
    ds_read_b64_tr_b16 v[234:235], v10 offset:2496
    ds_read_b64_tr_b16 v[236:237], v11 offset:192
    ds_read_b64_tr_b16 v[238:239], v11 offset:2496
    ds_read_b64_tr_b16 v[240:241], v10 offset:256
    ds_read_b64_tr_b16 v[242:243], v10 offset:2560
    s_mov_b32 s51, 0
    s_setprio 2
    s_waitcnt lgkmcnt(0)
k1_loop_ffn:
    s_waitcnt lgkmcnt(15)
    v_mfma_f32_16x16x32_bf16 v[32:35], v[176:179], v[208:211], v[32:35]
    ds_read_b128 v[192:195], v9 offset:0
    v_mfma_f32_16x16x32_bf16 v[36:39], v[180:183], v[208:211], v[36:39]
    ds_read_b128 v[196:199], v9 offset:2048
    v_mfma_f32_16x16x32_bf16 v[40:43], v[184:187], v[208:211], v[40:43]
    ds_read_b128 v[200:203], v9 offset:4096
    v_mfma_f32_16x16x32_bf16 v[44:47], v[188:191], v[208:211], v[44:47]
    ds_read_b128 v[204:207], v9 offset:6144
    s_waitcnt lgkmcnt(15)
    v_mfma_f32_16x16x32_bf16 v[48:51], v[176:179], v[212:215], v[48:51]
    ds_read_b64_tr_b16 v[208:209], v10 offset:18432
    v_mfma_f32_16x16x32_bf16 v[52:55], v[180:183], v[212:215], v[52:55]
    ds_read_b64_tr_b16 v[210:211], v10 offset:20736
    v_mfma_f32_16x16x32_bf16 v[56:59], v[184:187], v[212:215], v[56:59]
    v_mfma_f32_16x16x32_bf16 v[60:63], v[188:191], v[212:215], v[60:63]
    v_mfma_f32_16x16x32_bf16 v[64:67], v[176:179], v[216:219], v[64:67]
    ds_read_b64_tr_b16 v[212:213], v11 offset:18432
    v_mfma_f32_16x16x32_bf16 v[68:71], v[180:183], v[216:219], v[68:71]
    ds_read_b64_tr_b16 v[214:215], v11 offset:20736
    v_mfma_f32_16x16x32_bf16 v[72:75], v[184:187], v[216:219], v[72:75]
    v_mfma_f32_16x16x32_bf16 v[76:79], v[188:191], v[216:219], v[76:79]
    s_waitcnt lgkmcnt(15)
    v_mfma_f32_16x16x32_bf16 v[80:83], v[176:179], v[220:223], v[80:83]
    ds_read_b64_tr_b16 v[216:217], v10 offset:18496
    v_mfma_f32_16x16x32_bf16 v[84:87], v[180:183], v[220:223], v[84:87]
    ds_read_b64_tr_b16 v[218:219], v10 offset:20800
    v_mfma_f32_16x16x32_bf16 v[88:91], v[184:187], v[220:223], v[88:91]
    v_mfma_f32_16x16x32_bf16 v[92:95], v[188:191], v[220:223], v[92:95]
    v_mfma_f32_16x16x32_bf16 v[96:99], v[176:179], v[224:227], v[96:99]
    ds_read_b64_tr_b16 v[220:221], v11 offset:18496
    v_mfma_f32_16x16x32_bf16 v[100:103], v[180:183], v[224:227], v[100:103]
    ds_read_b64_tr_b16 v[222:223], v11 offset:20800
    v_mfma_f32_16x16x32_bf16 v[104:107], v[184:187], v[224:227], v[104:107]
    v_mfma_f32_16x16x32_bf16 v[108:111], v[188:191], v[224:227], v[108:111]
    s_waitcnt lgkmcnt(15)
    v_mfma_f32_16x16x32_bf16 v[112:115], v[176:179], v[228:231], v[112:115]
    ds_read_b64_tr_b16 v[224:225], v10 offset:18560
    v_mfma_f32_16x16x32_bf16 v[116:119], v[180:183], v[228:231], v[116:119]
    ds_read_b64_tr_b16 v[226:227], v10 offset:20864
    v_mfma_f32_16x16x32_bf16 v[120:123], v[184:187], v[228:231], v[120:123]
    v_mfma_f32_16x16x32_bf16 v[124:127], v[188:191], v[228:231], v[124:127]
    v_mfma_f32_16x16x32_bf16 v[128:131], v[176:179], v[232:235], v[128:131]
    ds_read_b64_tr_b16 v[228:229], v11 offset:18560
    v_mfma_f32_16x16x32_bf16 v[132:135], v[180:183], v[232:235], v[132:135]
    ds_read_b64_tr_b16 v[230:231], v11 offset:20864
    v_mfma_f32_16x16x32_bf16 v[136:139], v[184:187], v[232:235], v[136:139]
    v_mfma_f32_16x16x32_bf16 v[140:143], v[188:191], v[232:235], v[140:143]
    s_waitcnt lgkmcnt(15)
    v_mfma_f32_16x16x32_bf16 v[144:147], v[176:179], v[236:239], v[144:147]
    ds_read_b64_tr_b16 v[232:233], v10 offset:18624
    v_mfma_f32_16x16x32_bf16 v[148:151], v[180:183], v[236:239], v[148:151]
    ds_read_b64_tr_b16 v[234:235], v10 offset:20928
    v_mfma_f32_16x16x32_bf16 v[152:155], v[184:187], v[236:239], v[152:155]
    v_mfma_f32_16x16x32_bf16 v[156:159], v[188:191], v[236:239], v[156:159]
    v_mfma_f32_16x16x32_bf16 v[160:163], v[176:179], v[240:243], v[160:163]
    ds_read_b64_tr_b16 v[236:237], v11 offset:18624
    v_mfma_f32_16x16x32_bf16 v[164:167], v[180:183], v[240:243], v[164:167]
    ds_read_b64_tr_b16 v[238:239], v11 offset:20928
    v_mfma_f32_16x16x32_bf16 v[168:171], v[184:187], v[240:243], v[168:171]
    v_mfma_f32_16x16x32_bf16 v[172:175], v[188:191], v[240:243], v[172:175]
    ds_read_b64_tr_b16 v[240:241], v10 offset:18688
    ds_read_b64_tr_b16 v[242:243], v10 offset:20992
    s_add_u32 s43, s43, 53248
    s_cmp_eq_u32 s43, 159744
    s_cselect_b32 s43, 0, s43
    s_waitcnt lgkmcnt(15)
    v_mfma_f32_16x16x32_bf16 v[32:35], v[192:195], v[208:211], v[32:35]
    v_mfma_f32_16x16x32_bf16 v[36:39], v[196:199], v[208:211], v[36:39]
    v_mfma_f32_16x16x32_bf16 v[40:43], v[200:203], v[208:211], v[40:43]
    v_mfma_f32_16x16x32_bf16 v[44:47], v[204:207], v[208:211], v[44:47]
    s_waitcnt lgkmcnt(14)
    v_mfma_f32_16x16x32_bf16 v[48:51], v[192:195], v[212:215], v[48:51]
    v_mfma_f32_16x16x32_bf16 v[52:55], v[196:199], v[212:215], v[52:55]
    v_mfma_f32_16x16x32_bf16 v[56:59], v[200:203], v[212:215], v[56:59]
    v_mfma_f32_16x16x32_bf16 v[60:63], v[204:207], v[212:215], v[60:63]
    s_waitcnt lgkmcnt(12)
    v_mfma_f32_16x16x32_bf16 v[64:67], v[192:195], v[216:219], v[64:67]
    v_mfma_f32_16x16x32_bf16 v[68:71], v[196:199], v[216:219], v[68:71]
    v_mfma_f32_16x16x32_bf16 v[72:75], v[200:203], v[216:219], v[72:75]
    v_mfma_f32_16x16x32_bf16 v[76:79], v[204:207], v[216:219], v[76:79]
    s_waitcnt lgkmcnt(0)
    v_add_u32 v8, s43, v2
    v_add_u32 v10, s43, v4
    v_add_u32 v9, s43, v3
    v_add_u32 v11, s43, v5
    s_barrier
    v_mfma_f32_16x16x32_bf16 v[80:83], v[192:195], v[220:223], v[80:83]
    ds_read_b128 v[176:179], v8 offset:0
    v_mfma_f32_16x16x32_bf16 v[84:87], v[196:199], v[220:223], v[84:87]
    ds_read_b128 v[180:183], v8 offset:2048
    v_mfma_f32_16x16x32_bf16 v[88:91], v[200:203], v[220:223], v[88:91]
    ds_read_b128 v[184:187], v8 offset:4096
    v_mfma_f32_16x16x32_bf16 v[92:95], v[204:207], v[220:223], v[92:95]
    ds_read_b128 v[188:191], v8 offset:6144
    v_mfma_f32_16x16x32_bf16 v[96:99], v[192:195], v[224:227], v[96:99]
    ds_read_b64_tr_b16 v[208:209], v10 offset:0
    v_mfma_f32_16x16x32_bf16 v[100:103], v[196:199], v[224:227], v[100:103]
    ds_read_b64_tr_b16 v[210:211], v10 offset:2304
    v_mfma_f32_16x16x32_bf16 v[104:107], v[200:203], v[224:227], v[104:107]
    ds_read_b64_tr_b16 v[212:213], v11 offset:0
    v_mfma_f32_16x16x32_bf16 v[108:111], v[204:207], v[224:227], v[108:111]
    ds_read_b64_tr_b16 v[214:215], v11 offset:2304
    v_mfma_f32_16x16x32_bf16 v[112:115], v[192:195], v[228:231], v[112:115]
    ds_read_b64_tr_b16 v[216:217], v10 offset:64
    v_mfma_f32_16x16x32_bf16 v[116:119], v[196:199], v[228:231], v[116:119]
    ds_read_b64_tr_b16 v[218:219], v10 offset:2368
    v_mfma_f32_16x16x32_bf16 v[120:123], v[200:203], v[228:231], v[120:123]
    ds_read_b64_tr_b16 v[220:221], v11 offset:64
    v_mfma_f32_16x16x32_bf16 v[124:127], v[204:207], v[228:231], v[124:127]
    ds_read_b64_tr_b16 v[222:223], v11 offset:2368
    v_mfma_f32_16x16x32_bf16 v[128:131], v[192:195], v[232:235], v[128:131]
    ds_read_b64_tr_b16 v[224:225], v10 offset:128
    v_mfma_f32_16x16x32_bf16 v[132:135], v[196:199], v[232:235], v[132:135]
    ds_read_b64_tr_b16 v[226:227], v10 offset:2432
    v_mfma_f32_16x16x32_bf16 v[136:139], v[200:203], v[232:235], v[136:139]
    ds_read_b64_tr_b16 v[228:229], v11 offset:128
    v_mfma_f32_16x16x32_bf16 v[140:143], v[204:207], v[232:235], v[140:143]
    ds_read_b64_tr_b16 v[230:231], v11 offset:2432
    v_mfma_f32_16x16x32_bf16 v[144:147], v[192:195], v[236:239], v[144:147]
    ds_read_b64_tr_b16 v[232:233], v10 offset:192
    v_mfma_f32_16x16x32_bf16 v[148:151], v[196:199], v[236:239], v[148:151]
    ds_read_b64_tr_b16 v[234:235], v10 offset:2496
    v_mfma_f32_16x16x32_bf16 v[152:155], v[200:203], v[236:239], v[152:155]
    v_mfma_f32_16x16x32_bf16 v[156:159], v[204:207], v[236:239], v[156:159]
    v_mfma_f32_16x16x32_bf16 v[160:163], v[192:195], v[240:243], v[160:163]
    ds_read_b64_tr_b16 v[236:237], v11 offset:192
    v_mfma_f32_16x16x32_bf16 v[164:167], v[196:199], v[240:243], v[164:167]
    ds_read_b64_tr_b16 v[238:239], v11 offset:2496
    v_mfma_f32_16x16x32_bf16 v[168:171], v[200:203], v[240:243], v[168:171]
    v_mfma_f32_16x16x32_bf16 v[172:175], v[204:207], v[240:243], v[172:175]
    ds_read_b64_tr_b16 v[240:241], v10 offset:256
    ds_read_b64_tr_b16 v[242:243], v10 offset:2560
    s_add_u32 s51, s51, 1
    s_cmp_lt_u32 s51, 8
    s_cbranch_scc1 k1_loop_ffn
    s_add_u32 s43, s43, 53248
    s_cmp_eq_u32 s43, 159744
    s_cselect_b32 s43, 0, s43
    v_add_u32 v244, s43, v2
    v_add_u32 v246, s43, v4
    v_add_u32 v245, s43, v3
    v_add_u32 v247, s43, v5
    s_waitcnt lgkmcnt(0)
    v_mfma_f32_16x16x32_bf16 v[32:35], v[176:179], v[208:211], v[32:35]
    ds_read_b128 v[192:195], v9 offset:0
    v_mfma_f32_16x16x32_bf16 v[36:39], v[180:183], v[208:211], v[36:39]
    ds_read_b128 v[196:199], v9 offset:2048
    v_mfma_f32_16x16x32_bf16 v[40:43], v[184:187], v[208:211], v[40:43]
    ds_read_b128 v[200:203], v9 offset:4096
    v_mfma_f32_16x16x32_bf16 v[44:47], v[188:191], v[208:211], v[44:47]
    ds_read_b128 v[204:207], v9 offset:6144
    v_mfma_f32_16x16x32_bf16 v[48:51], v[176:179], v[212:215], v[48:51]
    ds_read_b64_tr_b16 v[220:221], v10 offset:18432
    v_mfma_f32_16x16x32_bf16 v[52:55], v[180:183], v[212:215], v[52:55]
    ds_read_b64_tr_b16 v[222:223], v10 offset:20736
    v_mfma_f32_16x16x32_bf16 v[56:59], v[184:187], v[212:215], v[56:59]
    ds_read_b64_tr_b16 v[224:225], v11 offset:18432
    v_mfma_f32_16x16x32_bf16 v[60:63], v[188:191], v[212:215], v[60:63]
    ds_read_b64_tr_b16 v[226:227], v11 offset:20736
    v_mfma_f32_16x16x32_bf16 v[64:67], v[176:179], v[216:219], v[64:67]
    ds_read_b64_tr_b16 v[228:229], v10 offset:18496
    v_mfma_f32_16x16x32_bf16 v[68:71], v[180:183], v[216:219], v[68:71]
    ds_read_b64_tr_b16 v[230:231], v10 offset:20800
    v_mfma_f32_16x16x32_bf16 v[72:75], v[184:187], v[216:219], v[72:75]
    v_mfma_f32_16x16x32_bf16 v[76:79], v[188:191], v[216:219], v[76:79]
    s_waitcnt lgkmcnt(0)
    v_mfma_f32_16x16x32_bf16 v[32:35], v[192:195], v[220:223], v[32:35]
    ds_read_b128 v[176:179], v8 offset:0
    v_mfma_f32_16x16x32_bf16 v[36:39], v[196:199], v[220:223], v[36:39]
    ds_read_b128 v[180:183], v8 offset:2048
    v_mfma_f32_16x16x32_bf16 v[40:43], v[200:203], v[220:223], v[40:43]
    ds_read_b128 v[184:187], v8 offset:4096
    v_mfma_f32_16x16x32_bf16 v[44:47], v[204:207], v[220:223], v[44:47]
    ds_read_b128 v[188:191], v8 offset:6144
    v_mfma_f32_16x16x32_bf16 v[48:51], v[192:195], v[224:227], v[48:51]
    ds_read_b64_tr_b16 v[232:233], v11 offset:64
    v_mfma_f32_16x16x32_bf16 v[52:55], v[196:199], v[224:227], v[52:55]
    ds_read_b64_tr_b16 v[234:235], v11 offset:2368
    v_mfma_f32_16x16x32_bf16 v[56:59], v[200:203], v[224:227], v[56:59]
    ds_read_b64_tr_b16 v[236:237], v10 offset:128
    v_mfma_f32_16x16x32_bf16 v[60:63], v[204:207], v[224:227], v[60:63]
    ds_read_b64_tr_b16 v[238:239], v10 offset:2432
    v_mfma_f32_16x16x32_bf16 v[64:67], v[192:195], v[228:231], v[64:67]
    ds_read_b64_tr_b16 v[240:241], v11 offset:128
    v_mfma_f32_16x16x32_bf16 v[68:71], v[196:199], v[228:231], v[68:71]
    ds_read_b64_tr_b16 v[242:243], v11 offset:2432
    v_mfma_f32_16x16x32_bf16 v[72:75], v[200:203], v[228:231], v[72:75]
    v_mfma_f32_16x16x32_bf16 v[76:79], v[204:207], v[228:231], v[76:79]
    s_waitcnt lgkmcnt(0)
    v_mfma_f32_16x16x32_bf16 v[80:83], v[176:179], v[232:235], v[80:83]
    ds_read_b128 v[192:195], v9 offset:0
    v_mfma_f32_16x16x32_bf16 v[84:87], v[180:183], v[232:235], v[84:87]
    ds_read_b128 v[196:199], v9 offset:2048
    v_mfma_f32_16x16x32_bf16 v[88:91], v[184:187], v[232:235], v[88:91]
    ds_read_b128 v[200:203], v9 offset:4096
    v_mfma_f32_16x16x32_bf16 v[92:95], v[188:191], v[232:235], v[92:95]
    ds_read_b128 v[204:207], v9 offset:6144
    v_mfma_f32_16x16x32_bf16 v[96:99], v[176:179], v[236:239], v[96:99]
    ds_read_b64_tr_b16 v[208:209], v11 offset:18496
    v_mfma_f32_16x16x32_bf16 v[100:103], v[180:183], v[236:239], v[100:103]
    ds_read_b64_tr_b16 v[210:211], v11 offset:20800
    v_mfma_f32_16x16x32_bf16 v[104:107], v[184:187], v[236:239], v[104:107]
    ds_read_b64_tr_b16 v[212:213], v10 offset:18560
    v_mfma_f32_16x16x32_bf16 v[108:111], v[188:191], v[236:239], v[108:111]
    ds_read_b64_tr_b16 v[214:215], v10 offset:20864
    v_mfma_f32_16x16x32_bf16 v[112:115], v[176:179], v[240:243], v[112:115]
    ds_read_b64_tr_b16 v[216:217], v11 offset:18560
    v_mfma_f32_16x16x32_bf16 v[116:119], v[180:183], v[240:243], v[116:119]
    ds_read_b64_tr_b16 v[218:219], v11 offset:20864
    v_mfma_f32_16x16x32_bf16 v[120:123], v[184:187], v[240:243], v[120:123]
    v_mfma_f32_16x16x32_bf16 v[124:127], v[188:191], v[240:243], v[124:127]
    s_waitcnt lgkmcnt(0)
    s_barrier
    s_barrier
    v_mfma_f32_16x16x32_bf16 v[80:83], v[192:195], v[208:211], v[80:83]
    ds_read_b128 v[176:179], v244 offset:0
    v_mfma_f32_16x16x32_bf16 v[84:87], v[196:199], v[208:211], v[84:87]
    ds_read_b128 v[180:183], v244 offset:2048
    v_mfma_f32_16x16x32_bf16 v[88:91], v[200:203], v[208:211], v[88:91]
    ds_read_b128 v[184:187], v244 offset:4096
    v_mfma_f32_16x16x32_bf16 v[92:95], v[204:207], v[208:211], v[92:95]
    ds_read_b128 v[188:191], v244 offset:6144
    v_mfma_f32_16x16x32_bf16 v[96:99], v[192:195], v[212:215], v[96:99]
    ds_read_b64_tr_b16 v[220:221], v246 offset:0
    v_mfma_f32_16x16x32_bf16 v[100:103], v[196:199], v[212:215], v[100:103]
    ds_read_b64_tr_b16 v[222:223], v246 offset:2304
    v_mfma_f32_16x16x32_bf16 v[104:107], v[200:203], v[212:215], v[104:107]
    ds_read_b64_tr_b16 v[224:225], v247 offset:0
    v_mfma_f32_16x16x32_bf16 v[108:111], v[204:207], v[212:215], v[108:111]
    ds_read_b64_tr_b16 v[226:227], v247 offset:2304
    v_mfma_f32_16x16x32_bf16 v[112:115], v[192:195], v[216:219], v[112:115]
    ds_read_b64_tr_b16 v[228:229], v246 offset:64
    v_mfma_f32_16x16x32_bf16 v[116:119], v[196:199], v[216:219], v[116:119]
    ds_read_b64_tr_b16 v[230:231], v246 offset:2368
    v_mfma_f32_16x16x32_bf16 v[120:123], v[200:203], v[216:219], v[120:123]
    v_mfma_f32_16x16x32_bf16 v[124:127], v[204:207], v[216:219], v[124:127]
    s_waitcnt lgkmcnt(0)
    v_mfma_f32_16x16x32_bf16 v[32:35], v[176:179], v[220:223], v[32:35]
    ds_read_b128 v[192:195], v245 offset:0
    v_mfma_f32_16x16x32_bf16 v[36:39], v[180:183], v[220:223], v[36:39]
    ds_read_b128 v[196:199], v245 offset:2048
    v_mfma_f32_16x16x32_bf16 v[40:43], v[184:187], v[220:223], v[40:43]
    ds_read_b128 v[200:203], v245 offset:4096
    v_mfma_f32_16x16x32_bf16 v[44:47], v[188:191], v[220:223], v[44:47]
    ds_read_b128 v[204:207], v245 offset:6144
    v_mfma_f32_16x16x32_bf16 v[48:51], v[176:179], v[224:227], v[48:51]
    ds_read_b64_tr_b16 v[232:233], v246 offset:18432
    v_mfma_f32_16x16x32_bf16 v[52:55], v[180:183], v[224:227], v[52:55]
    ds_read_b64_tr_b16 v[234:235], v246 offset:20736
    v_mfma_f32_16x16x32_bf16 v[56:59], v[184:187], v[224:227], v[56:59]
    ds_read_b64_tr_b16 v[236:237], v247 offset:18432
    v_mfma_f32_16x16x32_bf16 v[60:63], v[188:191], v[224:227], v[60:63]
    ds_read_b64_tr_b16 v[238:239], v247 offset:20736
    v_mfma_f32_16x16x32_bf16 v[64:67], v[176:179], v[228:231], v[64:67]
    ds_read_b64_tr_b16 v[240:241], v246 offset:18496
    v_mfma_f32_16x16x32_bf16 v[68:71], v[180:183], v[228:231], v[68:71]
    ds_read_b64_tr_b16 v[242:243], v246 offset:20800
    v_mfma_f32_16x16x32_bf16 v[72:75], v[184:187], v[228:231], v[72:75]
    v_mfma_f32_16x16x32_bf16 v[76:79], v[188:191], v[228:231], v[76:79]
    s_waitcnt lgkmcnt(0)
    v_mfma_f32_16x16x32_bf16 v[32:35], v[192:195], v[232:235], v[32:35]
    ds_read_b128 v[176:179], v8 offset:0
    v_mfma_f32_16x16x32_bf16 v[36:39], v[196:199], v[232:235], v[36:39]
    ds_read_b128 v[180:183], v8 offset:2048
    v_mfma_f32_16x16x32_bf16 v[40:43], v[200:203], v[232:235], v[40:43]
    ds_read_b128 v[184:187], v8 offset:4096
    v_mfma_f32_16x16x32_bf16 v[44:47], v[204:207], v[232:235], v[44:47]
    ds_read_b128 v[188:191], v8 offset:6144
    v_mfma_f32_16x16x32_bf16 v[48:51], v[192:195], v[236:239], v[48:51]
    ds_read_b64_tr_b16 v[208:209], v10 offset:192
    v_mfma_f32_16x16x32_bf16 v[52:55], v[196:199], v[236:239], v[52:55]
    ds_read_b64_tr_b16 v[210:211], v10 offset:2496
    v_mfma_f32_16x16x32_bf16 v[56:59], v[200:203], v[236:239], v[56:59]
    ds_read_b64_tr_b16 v[212:213], v11 offset:192
    v_mfma_f32_16x16x32_bf16 v[60:63], v[204:207], v[236:239], v[60:63]
    ds_read_b64_tr_b16 v[214:215], v11 offset:2496
    v_mfma_f32_16x16x32_bf16 v[64:67], v[192:195], v[240:243], v[64:67]
    ds_read_b64_tr_b16 v[216:217], v10 offset:256
    v_mfma_f32_16x16x32_bf16 v[68:71], v[196:199], v[240:243], v[68:71]
    ds_read_b64_tr_b16 v[218:219], v10 offset:2560
    v_mfma_f32_16x16x32_bf16 v[72:75], v[200:203], v[240:243], v[72:75]
    v_mfma_f32_16x16x32_bf16 v[76:79], v[204:207], v[240:243], v[76:79]
    s_waitcnt lgkmcnt(0)
    v_mfma_f32_16x16x32_bf16 v[128:131], v[176:179], v[208:211], v[128:131]
    ds_read_b128 v[192:195], v9 offset:0
    v_mfma_f32_16x16x32_bf16 v[132:135], v[180:183], v[208:211], v[132:135]
    ds_read_b128 v[196:199], v9 offset:2048
    v_cvt_pk_bf16_f32 v18, v32, v34
    v_cvt_pk_bf16_f32 v19, v36, v38
    v_cvt_pk_bf16_f32 v20, v40, v42
    v_cvt_pk_bf16_f32 v21, v44, v46
    v_mfma_f32_16x16x32_bf16 v[136:139], v[184:187], v[208:211], v[136:139]
    ds_read_b128 v[200:203], v9 offset:4096
    v_cvt_pk_bf16_f32 v22, v33, v35
    v_cvt_pk_bf16_f32 v23, v37, v39
    v_cvt_pk_bf16_f32 v24, v41, v43
    v_cvt_pk_bf16_f32 v25, v45, v47
    v_mfma_f32_16x16x32_bf16 v[140:143], v[188:191], v[208:211], v[140:143]
    ds_read_b128 v[204:207], v9 offset:6144
    v_pk_max_i16 v18, v18, 0
    v_pk_max_i16 v19, v19, 0
    v_pk_max_i16 v20, v20, 0
    v_pk_max_i16 v21, v21, 0
    v_mfma_f32_16x16x32_bf16 v[144:147], v[176:179], v[212:215], v[144:147]
    ds_read_b64_tr_b16 v[220:221], v10 offset:18624
    v_pk_max_i16 v22, v22, 0
    v_pk_max_i16 v23, v23, 0
    v_pk_max_i16 v24, v24, 0
    v_pk_max_i16 v25, v25, 0
    v_mfma_f32_16x16x32_bf16 v[148:151], v[180:183], v[212:215], v[148:151]
    ds_read_b64_tr_b16 v[222:223], v10 offset:20928
    v_mov_b32 v26, v22
    v_mov_b32 v27, v23
    v_mov_b32 v28, v24
    v_mov_b32 v29, v25
    v_mfma_f32_16x16x32_bf16 v[152:155], v[184:187], v[212:215], v[152:155]
    ds_read_b64_tr_b16 v[224:225], v11 offset:18624
    v_mov_b32_dpp v22, v18 row_ror:8 row_mask:0xf bank_mask:0x3
    v_mov_b32_dpp v23, v19 row_ror:8 row_mask:0xf bank_mask:0x3
    v_mov_b32_dpp v24, v20 row_ror:8 row_mask:0xf bank_mask:0x3
    v_mov_b32_dpp v25, v21 row_ror:8 row_mask:0xf bank_mask:0x3
    v_mfma_f32_16x16x32_bf16 v[156:159], v[188:191], v[212:215], v[156:159]
    ds_read_b64_tr_b16 v[226:227], v11 offset:20928
    v_mov_b32_dpp v18, v26 row_ror:8 row_mask:0xf bank_mask:0xc
    v_mov_b32_dpp v19, v27 row_ror:8 row_mask:0xf bank_mask:0xc
    v_mov_b32_dpp v20, v28 row_ror:8 row_mask:0xf bank_mask:0xc
    v_mov_b32_dpp v21, v29 row_ror:8 row_mask:0xf bank_mask:0xc
    v_mfma_f32_16x16x32_bf16 v[160:163], v[176:179], v[216:219], v[160:163]
    ds_read_b64_tr_b16 v[228:229], v10 offset:18688
    s_mov_b32 s49, 0
    buffer_store_dwordx4 v[18:21], v17, s[20:23], s49 offen sc1
    buffer_store_dwordx4 v[22:25], v13, s[20:23], s49 offen sc1
    v_cvt_pk_bf16_f32 v248, v48, v50
    v_mfma_f32_16x16x32_bf16 v[164:167], v[180:183], v[216:219], v[164:167]
    ds_read_b64_tr_b16 v[230:231], v10 offset:20992
    v_cvt_pk_bf16_f32 v249, v52, v54
    v_cvt_pk_bf16_f32 v250, v56, v58
    v_cvt_pk_bf16_f32 v251, v60, v62
    v_cvt_pk_bf16_f32 v252, v49, v51
    v_mfma_f32_16x16x32_bf16 v[168:171], v[184:187], v[216:219], v[168:171]
    v_cvt_pk_bf16_f32 v253, v53, v55
    v_cvt_pk_bf16_f32 v254, v57, v59
    v_cvt_pk_bf16_f32 v255, v61, v63
    v_pk_max_i16 v248, v248, 0
    v_mfma_f32_16x16x32_bf16 v[172:175], v[188:191], v[216:219], v[172:175]
    v_pk_max_i16 v249, v249, 0
    v_pk_max_i16 v250, v250, 0
    v_pk_max_i16 v251, v251, 0
    v_pk_max_i16 v252, v252, 0
    s_waitcnt lgkmcnt(0)
    v_mfma_f32_16x16x32_bf16 v[128:131], v[192:195], v[220:223], v[128:131]
    ds_read_b128 v[176:179], v244 offset:0
    v_mfma_f32_16x16x32_bf16 v[132:135], v[196:199], v[220:223], v[132:135]
    ds_read_b128 v[180:183], v244 offset:2048
    v_pk_max_i16 v253, v253, 0
    v_pk_max_i16 v254, v254, 0
    v_pk_max_i16 v255, v255, 0
    v_mov_b32 v26, v252
    v_mfma_f32_16x16x32_bf16 v[136:139], v[200:203], v[220:223], v[136:139]
    ds_read_b128 v[184:187], v244 offset:4096
    v_mov_b32 v27, v253
    v_mov_b32 v28, v254
    v_mov_b32 v29, v255
    v_mov_b32_dpp v252, v248 row_ror:8 row_mask:0xf bank_mask:0x3
    v_mfma_f32_16x16x32_bf16 v[140:143], v[204:207], v[220:223], v[140:143]
    ds_read_b128 v[188:191], v244 offset:6144
    v_mov_b32_dpp v253, v249 row_ror:8 row_mask:0xf bank_mask:0x3
    v_mov_b32_dpp v254, v250 row_ror:8 row_mask:0xf bank_mask:0x3
    v_mov_b32_dpp v255, v251 row_ror:8 row_mask:0xf bank_mask:0x3
    v_mov_b32_dpp v248, v26 row_ror:8 row_mask:0xf bank_mask:0xc
    v_mfma_f32_16x16x32_bf16 v[144:147], v[192:195], v[224:227], v[144:147]
    ds_read_b64_tr_b16 v[232:233], v247 offset:64
    v_mov_b32_dpp v249, v27 row_ror:8 row_mask:0xf bank_mask:0xc
    v_mov_b32_dpp v250, v28 row_ror:8 row_mask:0xf bank_mask:0xc
    v_mov_b32_dpp v251, v29 row_ror:8 row_mask:0xf bank_mask:0xc
    s_mov_b32 s49, 2048
    v_mfma_f32_16x16x32_bf16 v[148:151], v[196:199], v[224:227], v[148:151]
    ds_read_b64_tr_b16 v[234:235], v247 offset:2368
    buffer_store_dwordx4 v[248:251], v17, s[20:23], s49 offen sc1
    buffer_store_dwordx4 v[252:255], v13, s[20:23], s49 offen sc1
    v_cvt_pk_bf16_f32 v18, v64, v66
    v_cvt_pk_bf16_f32 v19, v68, v70
    v_mfma_f32_16x16x32_bf16 v[152:155], v[200:203], v[224:227], v[152:155]
    ds_read_b64_tr_b16 v[236:237], v246 offset:128
    v_cvt_pk_bf16_f32 v20, v72, v74
    v_cvt_pk_bf16_f32 v21, v76, v78
    v_cvt_pk_bf16_f32 v22, v65, v67
    v_cvt_pk_bf16_f32 v23, v69, v71
    v_mfma_f32_16x16x32_bf16 v[156:159], v[204:207], v[224:227], v[156:159]
    ds_read_b64_tr_b16 v[238:239], v246 offset:2432
    v_cvt_pk_bf16_f32 v24, v73, v75
    v_cvt_pk_bf16_f32 v25, v77, v79
    v_pk_max_i16 v18, v18, 0
    v_pk_max_i16 v19, v19, 0
    v_mfma_f32_16x16x32_bf16 v[160:163], v[192:195], v[228:231], v[160:163]
    ds_read_b64_tr_b16 v[240:241], v247 offset:128
    v_pk_max_i16 v20, v20, 0
    v_pk_max_i16 v21, v21, 0
    v_pk_max_i16 v22, v22, 0
    v_pk_max_i16 v23, v23, 0
    v_mfma_f32_16x16x32_bf16 v[164:167], v[196:199], v[228:231], v[164:167]
    ds_read_b64_tr_b16 v[242:243], v247 offset:2432
    v_pk_max_i16 v24, v24, 0
    v_pk_max_i16 v25, v25, 0
    v_mov_b32 v26, v22
    v_mov_b32 v27, v23
    v_mfma_f32_16x16x32_bf16 v[168:171], v[200:203], v[228:231], v[168:171]
    v_mov_b32 v28, v24
    v_mov_b32 v29, v25
    v_mov_b32_dpp v22, v18 row_ror:8 row_mask:0xf bank_mask:0x3
    v_mov_b32_dpp v23, v19 row_ror:8 row_mask:0xf bank_mask:0x3
    v_mfma_f32_16x16x32_bf16 v[172:175], v[204:207], v[228:231], v[172:175]
    v_mov_b32_dpp v24, v20 row_ror:8 row_mask:0xf bank_mask:0x3
    v_mov_b32_dpp v25, v21 row_ror:8 row_mask:0xf bank_mask:0x3
    v_mov_b32_dpp v18, v26 row_ror:8 row_mask:0xf bank_mask:0xc
    v_mov_b32_dpp v19, v27 row_ror:8 row_mask:0xf bank_mask:0xc
    s_waitcnt lgkmcnt(0)
    v_mfma_f32_16x16x32_bf16 v[80:83], v[176:179], v[232:235], v[80:83]
    ds_read_b128 v[192:195], v245 offset:0
    v_mfma_f32_16x16x32_bf16 v[84:87], v[180:183], v[232:235], v[84:87]
    ds_read_b128 v[196:199], v245 offset:2048
    v_mov_b32_dpp v20, v28 row_ror:8 row_mask:0xf bank_mask:0xc
    v_mov_b32_dpp v21, v29 row_ror:8 row_mask:0xf bank_mask:0xc
    s_mov_b32 s49, 4096
    buffer_store_dwordx4 v[18:21], v17, s[20:23], s49 offen sc1
    v_mfma_f32_16x16x32_bf16 v[88:91], v[184:187], v[232:235], v[88:91]
    ds_read_b128 v[200:203], v245 offset:4096
    buffer_store_dwordx4 v[22:25], v13, s[20:23], s49 offen sc1
    v_mfma_f32_16x16x32_bf16 v[92:95], v[188:191], v[232:235], v[92:95]
    ds_read_b128 v[204:207], v245 offset:6144
    v_mfma_f32_16x16x32_bf16 v[96:99], v[176:179], v[236:239], v[96:99]
    ds_read_b64_tr_b16 v[208:209], v247 offset:18496
    v_mfma_f32_16x16x32_bf16 v[100:103], v[180:183], v[236:239], v[100:103]
    ds_read_b64_tr_b16 v[210:211], v247 offset:20800
    v_mfma_f32_16x16x32_bf16 v[104:107], v[184:187], v[236:239], v[104:107]
    ds_read_b64_tr_b16 v[212:213], v246 offset:18560
    v_mfma_f32_16x16x32_bf16 v[108:111], v[188:191], v[236:239], v[108:111]
    ds_read_b64_tr_b16 v[214:215], v246 offset:20864
    v_mfma_f32_16x16x32_bf16 v[112:115], v[176:179], v[240:243], v[112:115]
    ds_read_b64_tr_b16 v[216:217], v247 offset:18560
    v_mfma_f32_16x16x32_bf16 v[116:119], v[180:183], v[240:243], v[116:119]
    ds_read_b64_tr_b16 v[218:219], v247 offset:20864
    v_mfma_f32_16x16x32_bf16 v[120:123], v[184:187], v[240:243], v[120:123]
    v_mfma_f32_16x16x32_bf16 v[124:127], v[188:191], v[240:243], v[124:127]
    s_waitcnt lgkmcnt(0)
    v_mfma_f32_16x16x32_bf16 v[80:83], v[192:195], v[208:211], v[80:83]
    ds_read_b128 v[176:179], v244 offset:0
    v_mfma_f32_16x16x32_bf16 v[84:87], v[196:199], v[208:211], v[84:87]
    ds_read_b128 v[180:183], v244 offset:2048
    v_mfma_f32_16x16x32_bf16 v[88:91], v[200:203], v[208:211], v[88:91]
    ds_read_b128 v[184:187], v244 offset:4096
    v_mfma_f32_16x16x32_bf16 v[92:95], v[204:207], v[208:211], v[92:95]
    ds_read_b128 v[188:191], v244 offset:6144
    v_mfma_f32_16x16x32_bf16 v[96:99], v[192:195], v[212:215], v[96:99]
    ds_read_b64_tr_b16 v[220:221], v246 offset:192
    v_mfma_f32_16x16x32_bf16 v[100:103], v[196:199], v[212:215], v[100:103]
    ds_read_b64_tr_b16 v[222:223], v246 offset:2496
    v_mfma_f32_16x16x32_bf16 v[104:107], v[200:203], v[212:215], v[104:107]
    ds_read_b64_tr_b16 v[224:225], v247 offset:192
    v_mfma_f32_16x16x32_bf16 v[108:111], v[204:207], v[212:215], v[108:111]
    ds_read_b64_tr_b16 v[226:227], v247 offset:2496
    v_mfma_f32_16x16x32_bf16 v[112:115], v[192:195], v[216:219], v[112:115]
    ds_read_b64_tr_b16 v[228:229], v246 offset:256
    v_mfma_f32_16x16x32_bf16 v[116:119], v[196:199], v[216:219], v[116:119]
    ds_read_b64_tr_b16 v[230:231], v246 offset:2560
    v_mfma_f32_16x16x32_bf16 v[120:123], v[200:203], v[216:219], v[120:123]
    v_mfma_f32_16x16x32_bf16 v[124:127], v[204:207], v[216:219], v[124:127]
    s_waitcnt lgkmcnt(0)
    v_mfma_f32_16x16x32_bf16 v[128:131], v[176:179], v[220:223], v[128:131]
    ds_read_b128 v[192:195], v245 offset:0
    v_mfma_f32_16x16x32_bf16 v[132:135], v[180:183], v[220:223], v[132:135]
    ds_read_b128 v[196:199], v245 offset:2048
    v_cvt_pk_bf16_f32 v248, v80, v82
    v_cvt_pk_bf16_f32 v249, v84, v86
    v_cvt_pk_bf16_f32 v250, v88, v90
    v_cvt_pk_bf16_f32 v251, v92, v94
    v_mfma_f32_16x16x32_bf16 v[136:139], v[184:187], v[220:223], v[136:139]
    ds_read_b128 v[200:203], v245 offset:4096
    v_cvt_pk_bf16_f32 v252, v81, v83
    v_cvt_pk_bf16_f32 v253, v85, v87
    v_cvt_pk_bf16_f32 v254, v89, v91
    v_cvt_pk_bf16_f32 v255, v93, v95
    v_mfma_f32_16x16x32_bf16 v[140:143], v[188:191], v[220:223], v[140:143]
    ds_read_b128 v[204:207], v245 offset:6144
    v_pk_max_i16 v248, v248, 0
    v_pk_max_i16 v249, v249, 0
    v_pk_max_i16 v250, v250, 0
    v_pk_max_i16 v251, v251, 0
    v_mfma_f32_16x16x32_bf16 v[144:147], v[176:179], v[224:227], v[144:147]
    ds_read_b64_tr_b16 v[232:233], v246 offset:18624
    v_pk_max_i16 v252, v252, 0
    v_pk_max_i16 v253, v253, 0
    v_pk_max_i16 v254, v254, 0
    v_pk_max_i16 v255, v255, 0
    v_mfma_f32_16x16x32_bf16 v[148:151], v[180:183], v[224:227], v[148:151]
    ds_read_b64_tr_b16 v[234:235], v246 offset:20928
    v_mov_b32 v26, v252
    v_mov_b32 v27, v253
    v_mov_b32 v28, v254
    v_mov_b32 v29, v255
    v_mfma_f32_16x16x32_bf16 v[152:155], v[184:187], v[224:227], v[152:155]
    ds_read_b64_tr_b16 v[236:237], v247 offset:18624
    v_mov_b32_dpp v252, v248 row_ror:8 row_mask:0xf bank_mask:0x3
    v_mov_b32_dpp v253, v249 row_ror:8 row_mask:0xf bank_mask:0x3
    v_mov_b32_dpp v254, v250 row_ror:8 row_mask:0xf bank_mask:0x3
    v_mov_b32_dpp v255, v251 row_ror:8 row_mask:0xf bank_mask:0x3
    v_mfma_f32_16x16x32_bf16 v[156:159], v[188:191], v[224:227], v[156:159]
    ds_read_b64_tr_b16 v[238:239], v247 offset:20928
    v_mov_b32_dpp v248, v26 row_ror:8 row_mask:0xf bank_mask:0xc
    v_mov_b32_dpp v249, v27 row_ror:8 row_mask:0xf bank_mask:0xc
    v_mov_b32_dpp v250, v28 row_ror:8 row_mask:0xf bank_mask:0xc
    v_mov_b32_dpp v251, v29 row_ror:8 row_mask:0xf bank_mask:0xc
    v_mfma_f32_16x16x32_bf16 v[160:163], v[176:179], v[228:231], v[160:163]
    ds_read_b64_tr_b16 v[240:241], v246 offset:18688
    s_mov_b32 s49, 6144
    buffer_store_dwordx4 v[248:251], v17, s[20:23], s49 offen sc1
    buffer_store_dwordx4 v[252:255], v13, s[20:23], s49 offen sc1
    v_cvt_pk_bf16_f32 v18, v96, v98
    v_mfma_f32_16x16x32_bf16 v[164:167], v[180:183], v[228:231], v[164:167]
    ds_read_b64_tr_b16 v[242:243], v246 offset:20992
    v_cvt_pk_bf16_f32 v19, v100, v102
    v_cvt_pk_bf16_f32 v20, v104, v106
    v_cvt_pk_bf16_f32 v21, v108, v110
    v_cvt_pk_bf16_f32 v22, v97, v99
    v_mfma_f32_16x16x32_bf16 v[168:171], v[184:187], v[228:231], v[168:171]
    v_cvt_pk_bf16_f32 v23, v101, v103
    v_cvt_pk_bf16_f32 v24, v105, v107
    v_cvt_pk_bf16_f32 v25, v109, v111
    v_pk_max_i16 v18, v18, 0
    v_mfma_f32_16x16x32_bf16 v[172:175], v[188:191], v[228:231], v[172:175]
    v_pk_max_i16 v19, v19, 0
    v_pk_max_i16 v20, v20, 0
    v_pk_max_i16 v21, v21, 0
    v_pk_max_i16 v22, v22, 0
    s_waitcnt lgkmcnt(0)
    v_mfma_f32_16x16x32_bf16 v[128:131], v[192:195], v[232:235], v[128:131]
    v_mfma_f32_16x16x32_bf16 v[132:135], v[196:199], v[232:235], v[132:135]
    v_pk_max_i16 v23, v23, 0
    v_pk_max_i16 v24, v24, 0
    v_pk_max_i16 v25, v25, 0
    v_mov_b32 v26, v22
    v_mfma_f32_16x16x32_bf16 v[136:139], v[200:203], v[232:235], v[136:139]
    v_mov_b32 v27, v23
    v_mov_b32 v28, v24
    v_mov_b32 v29, v25
    v_mov_b32_dpp v22, v18 row_ror:8 row_mask:0xf bank_mask:0x3
    v_mfma_f32_16x16x32_bf16 v[140:143], v[204:207], v[232:235], v[140:143]
    v_mov_b32_dpp v23, v19 row_ror:8 row_mask:0xf bank_mask:0x3
    v_mov_b32_dpp v24, v20 row_ror:8 row_mask:0xf bank_mask:0x3
    v_mov_b32_dpp v25, v21 row_ror:8 row_mask:0xf bank_mask:0x3
    v_mov_b32_dpp v18, v26 row_ror:8 row_mask:0xf bank_mask:0xc
    v_mfma_f32_16x16x32_bf16 v[144:147], v[192:195], v[236:239], v[144:147]
    v_mov_b32_dpp v19, v27 row_ror:8 row_mask:0xf bank_mask:0xc
    v_mov_b32_dpp v20, v28 row_ror:8 row_mask:0xf bank_mask:0xc
    v_mov_b32_dpp v21, v29 row_ror:8 row_mask:0xf bank_mask:0xc
    s_mov_b32 s49, 8192
    v_mfma_f32_16x16x32_bf16 v[148:151], v[196:199], v[236:239], v[148:151]
    buffer_store_dwordx4 v[18:21], v17, s[20:23], s49 offen sc1
    buffer_store_dwordx4 v[22:25], v13, s[20:23], s49 offen sc1
    v_cvt_pk_bf16_f32 v248, v112, v114
    v_cvt_pk_bf16_f32 v249, v116, v118
    v_mfma_f32_16x16x32_bf16 v[152:155], v[200:203], v[236:239], v[152:155]
    v_cvt_pk_bf16_f32 v250, v120, v122
    v_cvt_pk_bf16_f32 v251, v124, v126
    v_cvt_pk_bf16_f32 v252, v113, v115
    v_cvt_pk_bf16_f32 v253, v117, v119
    v_mfma_f32_16x16x32_bf16 v[156:159], v[204:207], v[236:239], v[156:159]
    v_cvt_pk_bf16_f32 v254, v121, v123
    v_cvt_pk_bf16_f32 v255, v125, v127
    v_pk_max_i16 v248, v248, 0
    v_pk_max_i16 v249, v249, 0
    v_mfma_f32_16x16x32_bf16 v[160:163], v[192:195], v[240:243], v[160:163]
    v_pk_max_i16 v250, v250, 0
    v_pk_max_i16 v251, v251, 0
    v_pk_max_i16 v252, v252, 0
    v_pk_max_i16 v253, v253, 0
    v_mfma_f32_16x16x32_bf16 v[164:167], v[196:199], v[240:243], v[164:167]
    v_pk_max_i16 v254, v254, 0
    v_pk_max_i16 v255, v255, 0
    v_mov_b32 v26, v252
    v_mov_b32 v27, v253
    v_mfma_f32_16x16x32_bf16 v[168:171], v[200:203], v[240:243], v[168:171]
    v_mov_b32 v28, v254
    v_mov_b32 v29, v255
    v_mov_b32_dpp v252, v248 row_ror:8 row_mask:0xf bank_mask:0x3
    v_mov_b32_dpp v253, v249 row_ror:8 row_mask:0xf bank_mask:0x3
    v_mfma_f32_16x16x32_bf16 v[172:175], v[204:207], v[240:243], v[172:175]
    v_mov_b32_dpp v254, v250 row_ror:8 row_mask:0xf bank_mask:0x3
    v_mov_b32_dpp v255, v251 row_ror:8 row_mask:0xf bank_mask:0x3
    v_mov_b32_dpp v248, v26 row_ror:8 row_mask:0xf bank_mask:0xc
    v_mov_b32_dpp v249, v27 row_ror:8 row_mask:0xf bank_mask:0xc
    s_nop 7
    v_mov_b32_dpp v250, v28 row_ror:8 row_mask:0xf bank_mask:0xc
    v_mov_b32_dpp v251, v29 row_ror:8 row_mask:0xf bank_mask:0xc
    s_mov_b32 s49, 10240
    buffer_store_dwordx4 v[248:251], v17, s[20:23], s49 offen sc1
    buffer_store_dwordx4 v[252:255], v13, s[20:23], s49 offen sc1
    v_cvt_pk_bf16_f32 v18, v128, v130
    v_cvt_pk_bf16_f32 v19, v132, v134
    v_cvt_pk_bf16_f32 v20, v136, v138
    v_cvt_pk_bf16_f32 v21, v140, v142
    v_cvt_pk_bf16_f32 v22, v129, v131
    v_cvt_pk_bf16_f32 v23, v133, v135
    v_cvt_pk_bf16_f32 v24, v137, v139
    v_cvt_pk_bf16_f32 v25, v141, v143
    v_pk_max_i16 v18, v18, 0
    v_pk_max_i16 v19, v19, 0
    v_pk_max_i16 v20, v20, 0
    v_pk_max_i16 v21, v21, 0
    v_pk_max_i16 v22, v22, 0
    v_pk_max_i16 v23, v23, 0
    v_pk_max_i16 v24, v24, 0
    v_pk_max_i16 v25, v25, 0
    v_mov_b32 v26, v22
    v_mov_b32 v27, v23
    v_mov_b32 v28, v24
    v_mov_b32 v29, v25
    v_mov_b32_dpp v22, v18 row_ror:8 row_mask:0xf bank_mask:0x3
    v_mov_b32_dpp v23, v19 row_ror:8 row_mask:0xf bank_mask:0x3
    v_mov_b32_dpp v24, v20 row_ror:8 row_mask:0xf bank_mask:0x3
    v_mov_b32_dpp v25, v21 row_ror:8 row_mask:0xf bank_mask:0x3
    v_mov_b32_dpp v18, v26 row_ror:8 row_mask:0xf bank_mask:0xc
    v_mov_b32_dpp v19, v27 row_ror:8 row_mask:0xf bank_mask:0xc
    v_mov_b32_dpp v20, v28 row_ror:8 row_mask:0xf bank_mask:0xc
    v_mov_b32_dpp v21, v29 row_ror:8 row_mask:0xf bank_mask:0xc
    s_mov_b32 s49, 12288
    buffer_store_dwordx4 v[18:21], v17, s[20:23], s49 offen sc1
    buffer_store_dwordx4 v[22:25], v13, s[20:23], s49 offen sc1
    v_cvt_pk_bf16_f32 v248, v144, v146
    v_cvt_pk_bf16_f32 v249, v148, v150
    v_cvt_pk_bf16_f32 v250, v152, v154
    v_cvt_pk_bf16_f32 v251, v156, v158
    v_cvt_pk_bf16_f32 v252, v145, v147
    v_cvt_pk_bf16_f32 v253, v149, v151
    v_cvt_pk_bf16_f32 v254, v153, v155
    v_cvt_pk_bf16_f32 v255, v157, v159
    v_pk_max_i16 v248, v248, 0
    v_pk_max_i16 v249, v249, 0
    v_pk_max_i16 v250, v250, 0
    v_pk_max_i16 v251, v251, 0
    v_pk_max_i16 v252, v252, 0
    v_pk_max_i16 v253, v253, 0
    v_pk_max_i16 v254, v254, 0
    v_pk_max_i16 v255, v255, 0
    v_mov_b32 v26, v252
    v_mov_b32 v27, v253
    v_mov_b32 v28, v254
    v_mov_b32 v29, v255
    v_mov_b32_dpp v252, v248 row_ror:8 row_mask:0xf bank_mask:0x3
    v_mov_b32_dpp v253, v249 row_ror:8 row_mask:0xf bank_mask:0x3
    v_mov_b32_dpp v254, v250 row_ror:8 row_mask:0xf bank_mask:0x3
    v_mov_b32_dpp v255, v251 row_ror:8 row_mask:0xf bank_mask:0x3
    v_mov_b32_dpp v248, v26 row_ror:8 row_mask:0xf bank_mask:0xc
    v_mov_b32_dpp v249, v27 row_ror:8 row_mask:0xf bank_mask:0xc
    v_mov_b32_dpp v250, v28 row_ror:8 row_mask:0xf bank_mask:0xc
    v_mov_b32_dpp v251, v29 row_ror:8 row_mask:0xf bank_mask:0xc
    s_mov_b32 s49, 14336
    buffer_store_dwordx4 v[248:251], v17, s[20:23], s49 offen sc1
    buffer_store_dwordx4 v[252:255], v13, s[20:23], s49 offen sc1
    v_cvt_pk_bf16_f32 v18, v160, v162
    v_cvt_pk_bf16_f32 v19, v164, v166
    v_cvt_pk_bf16_f32 v20, v168, v170
    v_cvt_pk_bf16_f32 v21, v172, v174
    v_cvt_pk_bf16_f32 v22, v161, v163
    v_cvt_pk_bf16_f32 v23, v165, v167
    v_cvt_pk_bf16_f32 v24, v169, v171
    v_cvt_pk_bf16_f32 v25, v173, v175
    v_pk_max_i16 v18, v18, 0
    v_pk_max_i16 v19, v19, 0
    v_pk_max_i16 v20, v20, 0
    v_pk_max_i16 v21, v21, 0
    v_pk_max_i16 v22, v22, 0
    v_pk_max_i16 v23, v23, 0
    v_pk_max_i16 v24, v24, 0
    v_pk_max_i16 v25, v25, 0
    v_mov_b32 v26, v22
    v_mov_b32 v27, v23
    v_mov_b32 v28, v24
    v_mov_b32 v29, v25
    v_mov_b32_dpp v22, v18 row_ror:8 row_mask:0xf bank_mask:0x3
    v_mov_b32_dpp v23, v19 row_ror:8 row_mask:0xf bank_mask:0x3
    v_mov_b32_dpp v24, v20 row_ror:8 row_mask:0xf bank_mask:0x3
    v_mov_b32_dpp v25, v21 row_ror:8 row_mask:0xf bank_mask:0x3
    v_mov_b32_dpp v18, v26 row_ror:8 row_mask:0xf bank_mask:0xc
    v_mov_b32_dpp v19, v27 row_ror:8 row_mask:0xf bank_mask:0xc
    v_mov_b32_dpp v20, v28 row_ror:8 row_mask:0xf bank_mask:0xc
    v_mov_b32_dpp v21, v29 row_ror:8 row_mask:0xf bank_mask:0xc
    s_mov_b32 s49, 16384
    buffer_store_dwordx4 v[18:21], v17, s[20:23], s49 offen sc1
    buffer_store_dwordx4 v[22:25], v13, s[20:23], s49 offen sc1
    s_endpgm
k1_loader:
    s_setprio 3
    s_sub_u32 s42, s42, 4
    v_and_b32 v1, 63, v0
    v_lshlrev_b32 v2, 4, v1
    s_lshl_b32 s47, s42, 12
    v_add_u32 v4, s47, v2
    v_add_u32 v5, s47, v2
    v_add_u32 v5, 1024, v5
    v_add_u32 v6, s47, v2
    v_add_u32 v6, 2048, v6
    v_add_u32 v7, s47, v2
    v_add_u32 v7, 3072, v7
    s_mov_b32 s43, 0
    s_mul_i32 s44, s40, 163840
    s_mov_b32 s45, 0
    v_lshrrev_b32 v2, 3, v1
    v_and_b32 v3, 7, v1
    s_cmp_ge_u32 s41, 10
    s_cbranch_scc1 k1_loader_ffn
    s_add_u32 s48, s47, 16384
    s_lshl_b32 s49, s41, 6
    s_lshr_b32 s50, s42, 1
    s_lshl_b32 s50, s50, 5
    s_add_u32 s49, s49, s50
    v_lshrrev_b32 v22, 4, v1
    v_add_u32 v20, s49, v2
    v_add_u32 v20, 0, v20
    v_mul_u32_u24 v20, 1280, v20
    v_add_u32 v21, 0, v22
    v_and_b32 v21, 7, v21
    v_xor_b32 v21, v21, v3
    v_lshl_add_u32 v8, v21, 4, v20
    v_add_u32 v20, s49, v2
    v_add_u32 v20, 8, v20
    v_mul_u32_u24 v20, 1280, v20
    v_add_u32 v21, 4, v22
    v_and_b32 v21, 7, v21
    v_xor_b32 v21, v21, v3
    v_lshl_add_u32 v9, v21, 4, v20
    v_add_u32 v20, s49, v2
    v_add_u32 v20, 16, v20
    v_mul_u32_u24 v20, 1280, v20
    v_add_u32 v21, 8, v22
    v_and_b32 v21, 7, v21
    v_xor_b32 v21, v21, v3
    v_lshl_add_u32 v10, v21, 4, v20
    v_add_u32 v20, s49, v2
    v_add_u32 v20, 24, v20
    v_mul_u32_u24 v20, 1280, v20
    v_add_u32 v21, 12, v22
    v_and_b32 v21, 7, v21
    v_xor_b32 v21, v21, v3
    v_lshl_add_u32 v11, v21, 4, v20
    s_waitcnt lgkmcnt(0)
    s_mov_b32 s8, s4
    s_mov_b32 s9, s5
    s_mov_b32 s10, 2621440
    s_mov_b32 s11, 0x00020000
    s_and_b32 s49, s42, 1
    s_cmp_eq_u32 s49, 0
    s_cselect_b32 s12, s6, s30
    s_cselect_b32 s13, s7, s31
    s_mov_b32 s14, 819200
    s_mov_b32 s15, 0x00020000
    s_lshl_b32 s49, s41, 6
    v_add_u32 v17, s49, v1
    s_add_u32 s16, s4, 14958592
    s_addc_u32 s17, s5, 0
    s_mov_b32 s18, 20480
    s_mov_b32 s19, 0x00020000
    s_add_u32 s20, s4, 14979072
    s_addc_u32 s21, s5, 0
    s_mov_b32 s22, 81920
    s_mov_b32 s23, 0x00020000
    v_lshlrev_b32 v18, 5, v17
    buffer_load_dwordx4 v[24:27], v18, s[16:19], 0 offen offset:8
    buffer_load_dwordx2 v[28:29], v18, s[16:19], 0 offen offset:24
    s_add_u32 s49, s43, s47
    s_add_u32 m0, s49, 0
    s_nop 0
    buffer_load_dwordx4 v4, s[8:11], s44 offen lds
    s_add_u32 m0, s49, 1024
    s_nop 0
    buffer_load_dwordx4 v5, s[8:11], s44 offen lds
    s_add_u32 m0, s49, 2048
    s_nop 0
    buffer_load_dwordx4 v6, s[8:11], s44 offen lds
    s_add_u32 m0, s49, 3072
    s_nop 0
    buffer_load_dwordx4 v7, s[8:11], s44 offen lds
    s_add_u32 s49, s43, s48
    s_add_u32 m0, s49, 0
    s_nop 0
    buffer_load_dwordx4 v8, s[12:15], s45 offen lds
    s_add_u32 m0, s49, 1024
    s_nop 0
    buffer_load_dwordx4 v9, s[12:15], s45 offen lds
    s_add_u32 m0, s49, 2048
    s_nop 0
    buffer_load_dwordx4 v10, s[12:15], s45 offen lds
    s_add_u32 m0, s49, 3072
    s_nop 0
    buffer_load_dwordx4 v11, s[12:15], s45 offen lds
    s_add_u32 s44, s44, 16384
    s_add_u32 s45, s45, 128
    s_add_u32 s43, s43, 32768
    s_cmp_eq_u32 s43, 163840
    s_cselect_b32 s43, 0, s43
    s_add_u32 s49, s43, s47
    s_add_u32 m0, s49, 0
    s_nop 0
    buffer_load_dwordx4 v4, s[8:11], s44 offen lds
    s_add_u32 m0, s49, 1024
    s_nop 0
    buffer_load_dwordx4 v5, s[8:11], s44 offen lds
    s_add_u32 m0, s49, 2048
    s_nop 0
    buffer_load_dwordx4 v6, s[8:11], s44 offen lds
    s_add_u32 m0, s49, 3072
    s_nop 0
    buffer_load_dwordx4 v7, s[8:11], s44 offen lds
    s_add_u32 s49, s43, s48
    s_add_u32 m0, s49, 0
    s_nop 0
    buffer_load_dwordx4 v8, s[12:15], s45 offen lds
    s_add_u32 m0, s49, 1024
    s_nop 0
    buffer_load_dwordx4 v9, s[12:15], s45 offen lds
    s_add_u32 m0, s49, 2048
    s_nop 0
    buffer_load_dwordx4 v10, s[12:15], s45 offen lds
    s_add_u32 m0, s49, 3072
    s_nop 0
    buffer_load_dwordx4 v11, s[12:15], s45 offen lds
    s_add_u32 s44, s44, 16384
    s_add_u32 s45, s45, 128
    s_add_u32 s43, s43, 32768
    s_cmp_eq_u32 s43, 163840
    s_cselect_b32 s43, 0, s43
    s_waitcnt vmcnt(8)
    s_barrier
    s_add_u32 s49, s43, s47
    s_add_u32 m0, s49, 0
    s_nop 0
    buffer_load_dwordx4 v4, s[8:11], s44 offen lds
    s_add_u32 m0, s49, 1024
    s_nop 0
    buffer_load_dwordx4 v5, s[8:11], s44 offen lds
    s_add_u32 m0, s49, 2048
    s_nop 0
    buffer_load_dwordx4 v6, s[8:11], s44 offen lds
    s_add_u32 m0, s49, 3072
    s_nop 0
    buffer_load_dwordx4 v7, s[8:11], s44 offen lds
    s_add_u32 s49, s43, s48
    s_add_u32 m0, s49, 0
    s_nop 0
    buffer_load_dwordx4 v8, s[12:15], s45 offen lds
    s_add_u32 m0, s49, 1024
    s_nop 0
    buffer_load_dwordx4 v9, s[12:15], s45 offen lds
    s_add_u32 m0, s49, 2048
    s_nop 0
    buffer_load_dwordx4 v10, s[12:15], s45 offen lds
    s_add_u32 m0, s49, 3072
    s_nop 0
    buffer_load_dwordx4 v11, s[12:15], s45 offen lds
    s_add_u32 s44, s44, 16384
    s_add_u32 s45, s45, 128
    s_add_u32 s43, s43, 32768
    s_cmp_eq_u32 s43, 163840
    s_cselect_b32 s43, 0, s43
    s_add_u32 s49, s43, s47
    s_add_u32 m0, s49, 0
    s_nop 0
    buffer_load_dwordx4 v4, s[8:11], s44 offen lds
    s_add_u32 m0, s49, 1024
    s_nop 0
    buffer_load_dwordx4 v5, s[8:11], s44 offen lds
    s_add_u32 m0, s49, 2048
    s_nop 0
    buffer_load_dwordx4 v6, s[8:11], s44 offen lds
    s_add_u32 m0, s49, 3072
    s_nop 0
    buffer_load_dwordx4 v7, s[8:11], s44 offen lds
    s_add_u32 s49, s43, s48
    s_add_u32 m0, s49, 0
    s_nop 0
    buffer_load_dwordx4 v8, s[12:15], s45 offen lds
    s_add_u32 m0, s49, 1024
    s_nop 0
    buffer_load_dwordx4 v9, s[12:15], s45 offen lds
    s_add_u32 m0, s49, 2048
    s_nop 0
    buffer_load_dwordx4 v10, s[12:15], s45 offen lds
    s_add_u32 m0, s49, 3072
    s_nop 0
    buffer_load_dwordx4 v11, s[12:15], s45 offen lds
    s_add_u32 s44, s44, 16384
    s_add_u32 s45, s45, 128
    s_add_u32 s43, s43, 32768
    s_cmp_eq_u32 s43, 163840
    s_cselect_b32 s43, 0, s43
    s_waitcnt vmcnt(16)
    s_barrier
    s_add_u32 s49, s43, s47
    s_add_u32 m0, s49, 0
    s_nop 0
    buffer_load_dwordx4 v4, s[8:11], s44 offen lds
    s_add_u32 m0, s49, 1024
    s_nop 0
    buffer_load_dwordx4 v5, s[8:11], s44 offen lds
    s_add_u32 m0, s49, 2048
    s_nop 0
    buffer_load_dwordx4 v6, s[8:11], s44 offen lds
    s_add_u32 m0, s49, 3072
    s_nop 0
    buffer_load_dwordx4 v7, s[8:11], s44 offen lds
    s_add_u32 s49, s43, s48
    s_add_u32 m0, s49, 0
    s_nop 0
    buffer_load_dwordx4 v8, s[12:15], s45 offen lds
    s_add_u32 m0, s49, 1024
    s_nop 0
    buffer_load_dwordx4 v9, s[12:15], s45 offen lds
    s_add_u32 m0, s49, 2048
    s_nop 0
    buffer_load_dwordx4 v10, s[12:15], s45 offen lds
    s_add_u32 m0, s49, 3072
    s_nop 0
    buffer_load_dwordx4 v11, s[12:15], s45 offen lds
    s_add_u32 s44, s44, 16384
    s_add_u32 s45, s45, 128
    s_add_u32 s43, s43, 32768
    s_cmp_eq_u32 s43, 163840
    s_cselect_b32 s43, 0, s43
    s_add_u32 s49, s43, s47
    s_add_u32 m0, s49, 0
    s_nop 0
    buffer_load_dwordx4 v4, s[8:11], s44 offen lds
    s_add_u32 m0, s49, 1024
    s_nop 0
    buffer_load_dwordx4 v5, s[8:11], s44 offen lds
    s_add_u32 m0, s49, 2048
    s_nop 0
    buffer_load_dwordx4 v6, s[8:11], s44 offen lds
    s_add_u32 m0, s49, 3072
    s_nop 0
    buffer_load_dwordx4 v7, s[8:11], s44 offen lds
    s_add_u32 s49, s43, s48
    s_add_u32 m0, s49, 0
    s_nop 0
    buffer_load_dwordx4 v8, s[12:15], s45 offen lds
    s_add_u32 m0, s49, 1024
    s_nop 0
    buffer_load_dwordx4 v9, s[12:15], s45 offen lds
    s_add_u32 m0, s49, 2048
    s_nop 0
    buffer_load_dwordx4 v10, s[12:15], s45 offen lds
    s_add_u32 m0, s49, 3072
    s_nop 0
    buffer_load_dwordx4 v11, s[12:15], s45 offen lds
    s_add_u32 s44, s44, 16384
    s_add_u32 s45, s45, 128
    s_add_u32 s43, s43, 32768
    s_cmp_eq_u32 s43, 163840
    s_cselect_b32 s43, 0, s43
    s_waitcnt vmcnt(24)
    s_barrier
    s_mov_b32 s51, 3
k1b_ld_loop:
    s_add_u32 s49, s43, s47
    s_add_u32 m0, s49, 0
    s_nop 0
    buffer_load_dwordx4 v4, s[8:11], s44 offen lds
    s_add_u32 m0, s49, 1024
    s_nop 0
    buffer_load_dwordx4 v5, s[8:11], s44 offen lds
    s_add_u32 m0, s49, 2048
    s_nop 0
    buffer_load_dwordx4 v6, s[8:11], s44 offen lds
    s_add_u32 m0, s49, 3072
    s_nop 0
    buffer_load_dwordx4 v7, s[8:11], s44 offen lds
    s_add_u32 s49, s43, s48
    s_add_u32 m0, s49, 0
    s_nop 0
    buffer_load_dwordx4 v8, s[12:15], s45 offen lds
    s_add_u32 m0, s49, 1024
    s_nop 0
    buffer_load_dwordx4 v9, s[12:15], s45 offen lds
    s_add_u32 m0, s49, 2048
    s_nop 0
    buffer_load_dwordx4 v10, s[12:15], s45 offen lds
    s_add_u32 m0, s49, 3072
    s_nop 0
    buffer_load_dwordx4 v11, s[12:15], s45 offen lds
    s_add_u32 s44, s44, 16384
    s_add_u32 s45, s45, 128
    s_add_u32 s43, s43, 32768
    s_cmp_eq_u32 s43, 163840
    s_cselect_b32 s43, 0, s43
    s_waitcnt vmcnt(24)
    s_barrier
    s_add_u32 s51, s51, 1
    s_cmp_le_u32 s51, 6
    s_cbranch_scc1 k1b_ld_loop
    s_cmp_ge_u32 s42, 2
    s_cbranch_scc1 k1_pack
    v_mov_b32 v30, v26
    v_mov_b32 v31, v27
    v_mul_f32 v14, v30, v30
    v_mul_f32 v15, v30, v31
    v_fma_f32 v30, -v31, v31, v14
    v_add_f32 v31, v15, v15
    v_mul_f32 v14, v30, v30
    v_mul_f32 v15, v30, v31
    v_fma_f32 v30, -v31, v31, v14
    v_add_f32 v31, v15, v15
    v_mul_f32 v14, v30, v30
    v_mul_f32 v15, v30, v31
    v_fma_f32 v30, -v31, v31, v14
    v_add_f32 v31, v15, v15
    v_mov_b32 v96, v28
    v_sub_f32 v112, 0, v29
    v_mul_f32 v97, v24, v96
    v_mul_f32 v113, v24, v112
    v_fma_f32 v97, -v25, v112, v97
    v_fma_f32 v113, v25, v96, v113
    v_mul_f32 v98, v24, v97
    v_mul_f32 v114, v24, v113
    v_fma_f32 v98, -v25, v113, v98
    v_fma_f32 v114, v25, v97, v114
    v_mul_f32 v99, v24, v98
    v_mul_f32 v115, v24, v114
    v_fma_f32 v99, -v25, v114, v99
    v_fma_f32 v115, v25, v98, v115
    v_mul_f32 v100, v24, v99
    v_mul_f32 v116, v24, v115
    v_fma_f32 v100, -v25, v115, v100
    v_fma_f32 v116, v25, v99, v116
    v_mul_f32 v101, v24, v100
    v_mul_f32 v117, v24, v116
    v_fma_f32 v101, -v25, v116, v101
    v_fma_f32 v117, v25, v100, v117
    v_mul_f32 v102, v24, v101
    v_mul_f32 v118, v24, v117
    v_fma_f32 v102, -v25, v117, v102
    v_fma_f32 v118, v25, v101, v118
    v_mul_f32 v103, v24, v102
    v_mul_f32 v119, v24, v118
    v_fma_f32 v103, -v25, v118, v103
    v_fma_f32 v119, v25, v102, v119
    v_mul_f32 v104, v24, v103
    v_mul_f32 v120, v24, v119
    v_fma_f32 v104, -v25, v119, v104
    v_fma_f32 v120, v25, v103, v120
    v_mul_f32 v105, v24, v104
    v_mul_f32 v121, v24, v120
    v_fma_f32 v105, -v25, v120, v105
    v_fma_f32 v121, v25, v104, v121
    v_mul_f32 v106, v24, v105
    v_mul_f32 v122, v24, v121
    v_fma_f32 v106, -v25, v121, v106
    v_fma_f32 v122, v25, v105, v122
    v_mul_f32 v107, v24, v106
    v_mul_f32 v123, v24, v122
    v_fma_f32 v107, -v25, v122, v107
    v_fma_f32 v123, v25, v106, v123
    v_mul_f32 v108, v24, v107
    v_mul_f32 v124, v24, v123
    v_fma_f32 v108, -v25, v123, v108
    v_fma_f32 v124, v25, v107, v124
    v_mul_f32 v109, v24, v108
    v_mul_f32 v125, v24, v124
    v_fma_f32 v109, -v25, v124, v109
    v_fma_f32 v125, v25, v108, v125
    v_mul_f32 v110, v24, v109
    v_mul_f32 v126, v24, v125
    v_fma_f32 v110, -v25, v125, v110
    v_fma_f32 v126, v25, v109, v126
    v_mul_f32 v111, v24, v110
    v_mul_f32 v127, v24, v126
    v_fma_f32 v111, -v25, v126, v111
    v_fma_f32 v127, v25, v110, v127
    s_waitcnt vmcnt(16)
    s_barrier
    s_waitcnt vmcnt(8)
    s_barrier
    s_waitcnt vmcnt(0)
    s_barrier
    s_barrier
    v_lshlrev_b32 v5, 6, v1
    s_mul_i32 s49, s40, 5120
    v_lshlrev_b32 v6, 3, v17
    v_add_u32 v6, s49, v6
    s_cmp_eq_u32 s42, 1
    s_cbranch_scc1 k1_poller
    ds_write_b128 v5, v[96:99] offset:16384
    ds_write_b128 v5, v[112:115] offset:20480
    ds_write_b128 v5, v[100:103] offset:16400
    ds_write_b128 v5, v[116:119] offset:20496
    ds_write_b128 v5, v[104:107] offset:16416
    ds_write_b128 v5, v[120:123] offset:20512
    ds_write_b128 v5, v[108:111] offset:16432
    ds_write_b128 v5, v[124:127] offset:20528
    s_waitcnt lgkmcnt(0)
    s_barrier
    ds_read_b128 v[32:35], v5 offset:0
    ds_read_b128 v[48:51], v5 offset:4096
    ds_read_b128 v[36:39], v5 offset:16
    ds_read_b128 v[52:55], v5 offset:4112
    ds_read_b128 v[40:43], v5 offset:32
    ds_read_b128 v[56:59], v5 offset:4128
    ds_read_b128 v[44:47], v5 offset:48
    ds_read_b128 v[60:63], v5 offset:4144
    s_waitcnt lgkmcnt(0)
    v_mov_b32 v65, v32
    v_mov_b32 v129, v48
    v_fma_f32 v66, v24, v65, v33
    v_fma_f32 v130, v24, v129, v49
    v_fma_f32 v66, -v25, v129, v66
    v_fma_f32 v130, v25, v65, v130
    v_fma_f32 v67, v24, v66, v34
    v_fma_f32 v131, v24, v130, v50
    v_fma_f32 v67, -v25, v130, v67
    v_fma_f32 v131, v25, v66, v131
    v_fma_f32 v68, v24, v67, v35
    v_fma_f32 v132, v24, v131, v51
    v_fma_f32 v68, -v25, v131, v68
    v_fma_f32 v132, v25, v67, v132
    v_fma_f32 v69, v24, v68, v36
    v_fma_f32 v133, v24, v132, v52
    v_fma_f32 v69, -v25, v132, v69
    v_fma_f32 v133, v25, v68, v133
    v_fma_f32 v70, v24, v69, v37
    v_fma_f32 v134, v24, v133, v53
    v_fma_f32 v70, -v25, v133, v70
    v_fma_f32 v134, v25, v69, v134
    v_fma_f32 v71, v24, v70, v38
    v_fma_f32 v135, v24, v134, v54
    v_fma_f32 v71, -v25, v134, v71
    v_fma_f32 v135, v25, v70, v135
    v_fma_f32 v72, v24, v71, v39
    v_fma_f32 v136, v24, v135, v55
    v_fma_f32 v72, -v25, v135, v72
    v_fma_f32 v136, v25, v71, v136
    v_fma_f32 v73, v24, v72, v40
    v_fma_f32 v137, v24, v136, v56
    v_fma_f32 v73, -v25, v136, v73
    v_fma_f32 v137, v25, v72, v137
    v_fma_f32 v74, v24, v73, v41
    v_fma_f32 v138, v24, v137, v57
    v_fma_f32 v74, -v25, v137, v74
    v_fma_f32 v138, v25, v73, v138
    v_fma_f32 v75, v24, v74, v42
    v_fma_f32 v139, v24, v138, v58
    v_fma_f32 v75, -v25, v138, v75
    v_fma_f32 v139, v25, v74, v139
    v_fma_f32 v76, v24, v75, v43
    v_fma_f32 v140, v24, v139, v59
    v_fma_f32 v76, -v25, v139, v76
    v_fma_f32 v140, v25, v75, v140
    v_fma_f32 v77, v24, v76, v44
    v_fma_f32 v141, v24, v140, v60
    v_fma_f32 v77, -v25, v140, v77
    v_fma_f32 v141, v25, v76, v141
    v_fma_f32 v78, v24, v77, v45
    v_fma_f32 v142, v24, v141, v61
    v_fma_f32 v78, -v25, v141, v78
    v_fma_f32 v142, v25, v77, v142
    v_fma_f32 v79, v24, v78, v46
    v_fma_f32 v143, v24, v142, v62
    v_fma_f32 v79, -v25, v142, v79
    v_fma_f32 v143, v25, v78, v143
    v_fma_f32 v80, v24, v79, v47
    v_fma_f32 v144, v24, v143, v63
    v_fma_f32 v80, -v25, v143, v80
    v_fma_f32 v144, v25, v79, v144
    v_mov_b32 v14, 0x7fc00000
    v_cmp_eq_u32 vcc, -1, v80
    s_nop 1
    v_cndmask_b32 v12, v80, v14, vcc
    v_cmp_eq_u32 vcc, -1, v144
    s_nop 1
    v_cndmask_b32 v13, v144, v14, vcc
    buffer_store_dwordx2 v[12:13], v6, s[20:23], 0 offen sc1
    v_mov_b32 v96, 0
    v_mov_b32 v112, 0
    v_mul_f32 v97, v28, v65
    v_mul_f32 v113, v28, v129
    v_fma_f32 v97, v29, v129, v97
    v_fma_f32 v113, -v29, v65, v113
    v_mul_f32 v98, v28, v66
    v_mul_f32 v114, v28, v130
    v_fma_f32 v98, v29, v130, v98
    v_fma_f32 v114, -v29, v66, v114
    v_mul_f32 v99, v28, v67
    v_mul_f32 v115, v28, v131
    v_fma_f32 v99, v29, v131, v99
    v_fma_f32 v115, -v29, v67, v115
    v_mul_f32 v100, v28, v68
    v_mul_f32 v116, v28, v132
    v_fma_f32 v100, v29, v132, v100
    v_fma_f32 v116, -v29, v68, v116
    v_mul_f32 v101, v28, v69
    v_mul_f32 v117, v28, v133
    v_fma_f32 v101, v29, v133, v101
    v_fma_f32 v117, -v29, v69, v117
    v_mul_f32 v102, v28, v70
    v_mul_f32 v118, v28, v134
    v_fma_f32 v102, v29, v134, v102
    v_fma_f32 v118, -v29, v70, v118
    v_mul_f32 v103, v28, v71
    v_mul_f32 v119, v28, v135
    v_fma_f32 v103, v29, v135, v103
    v_fma_f32 v119, -v29, v71, v119
    v_mul_f32 v104, v28, v72
    v_mul_f32 v120, v28, v136
    v_fma_f32 v104, v29, v136, v104
    v_fma_f32 v120, -v29, v72, v120
    v_mul_f32 v105, v28, v73
    v_mul_f32 v121, v28, v137
    v_fma_f32 v105, v29, v137, v105
    v_fma_f32 v121, -v29, v73, v121
    v_mul_f32 v106, v28, v74
    v_mul_f32 v122, v28, v138
    v_fma_f32 v106, v29, v138, v106
    v_fma_f32 v122, -v29, v74, v122
    v_mul_f32 v107, v28, v75
    v_mul_f32 v123, v28, v139
    v_fma_f32 v107, v29, v139, v107
    v_fma_f32 v123, -v29, v75, v123
    v_mul_f32 v108, v28, v76
    v_mul_f32 v124, v28, v140
    v_fma_f32 v108, v29, v140, v108
    v_fma_f32 v124, -v29, v76, v124
    v_mul_f32 v109, v28, v77
    v_mul_f32 v125, v28, v141
    v_fma_f32 v109, v29, v141, v109
    v_fma_f32 v125, -v29, v77, v125
    v_mul_f32 v110, v28, v78
    v_mul_f32 v126, v28, v142
    v_fma_f32 v110, v29, v142, v110
    v_fma_f32 v126, -v29, v78, v126
    v_mul_f32 v111, v28, v79
    v_mul_f32 v127, v28, v143
    v_fma_f32 v111, v29, v143, v111
    v_fma_f32 v127, -v29, v79, v127
    ds_write_b128 v5, v[96:99] offset:8192
    ds_write_b128 v5, v[112:115] offset:12288
    ds_write_b128 v5, v[100:103] offset:8208
    ds_write_b128 v5, v[116:119] offset:12304
    ds_write_b128 v5, v[104:107] offset:8224
    ds_write_b128 v5, v[120:123] offset:12320
    ds_write_b128 v5, v[108:111] offset:8240
    ds_write_b128 v5, v[124:127] offset:12336
    s_waitcnt lgkmcnt(0)
    s_barrier
    s_waitcnt vmcnt(0)
    s_endpgm
k1_poller:
    v_subrev_u32 v48, 5120, v6
    v_subrev_u32 v49, 10240, v6
    v_subrev_u32 v50, 15360, v6
    v_subrev_u32 v51, 20480, v6
    v_subrev_u32 v52, 25600, v6
    v_subrev_u32 v53, 30720, v6
    v_subrev_u32 v54, 35840, v6
    v_subrev_u32 v55, 40960, v6
    v_subrev_u32 v56, 46080, v6
    v_subrev_u32 v57, 51200, v6
    v_subrev_u32 v58, 56320, v6
    v_subrev_u32 v59, 61440, v6
    v_subrev_u32 v60, 66560, v6
    v_subrev_u32 v61, 71680, v6
    v_subrev_u32 v62, 76800, v6
    v_lshlrev_b32 v5, 3, v1
    s_mov_b32 s51, 0
    s_barrier
    buffer_load_dwordx2 v[64:65], v48, s[20:23], 0 offen sc1
    buffer_load_dwordx2 v[66:67], v49, s[20:23], 0 offen sc1
    buffer_load_dwordx2 v[68:69], v50, s[20:23], 0 offen sc1
    buffer_load_dwordx2 v[70:71], v51, s[20:23], 0 offen sc1
    buffer_load_dwordx2 v[72:73], v52, s[20:23], 0 offen sc1
    buffer_load_dwordx2 v[74:75], v53, s[20:23], 0 offen sc1
    buffer_load_dwordx2 v[76:77], v54, s[20:23], 0 offen sc1
    buffer_load_dwordx2 v[78:79], v55, s[20:23], 0 offen sc1
    buffer_load_dwordx2 v[80:81], v56, s[20:23], 0 offen sc1
    buffer_load_dwordx2 v[82:83], v57, s[20:23], 0 offen sc1
    buffer_load_dwordx2 v[84:85], v58, s[20:23], 0 offen sc1
    buffer_load_dwordx2 v[86:87], v59, s[20:23], 0 offen sc1
    buffer_load_dwordx2 v[88:89], v60, s[20:23], 0 offen sc1
    buffer_load_dwordx2 v[90:91], v61, s[20:23], 0 offen sc1
    buffer_load_dwordx2 v[92:93], v62, s[20:23], 0 offen sc1
k1_poll:
    s_add_u32 s51, s51, 1
    s_cmp_gt_u32 s51, 100000
    s_cbranch_scc1 k1_poll_out
    buffer_load_dwordx2 v[96:97], v48, s[20:23], 0 offen sc1
    buffer_load_dwordx2 v[98:99], v49, s[20:23], 0 offen sc1
    buffer_load_dwordx2 v[100:101], v50, s[20:23], 0 offen sc1
    buffer_load_dwordx2 v[102:103], v51, s[20:23], 0 offen sc1
    buffer_load_dwordx2 v[104:105], v52, s[20:23], 0 offen sc1
    buffer_load_dwordx2 v[106:107], v53, s[20:23], 0 offen sc1
    buffer_load_dwordx2 v[108:109], v54, s[20:23], 0 offen sc1
    buffer_load_dwordx2 v[110:111], v55, s[20:23], 0 offen sc1
    buffer_load_dwordx2 v[112:113], v56, s[20:23], 0 offen sc1
    buffer_load_dwordx2 v[114:115], v57, s[20:23], 0 offen sc1
    buffer_load_dwordx2 v[116:117], v58, s[20:23], 0 offen sc1
    buffer_load_dwordx2 v[118:119], v59, s[20:23], 0 offen sc1
    buffer_load_dwordx2 v[120:121], v60, s[20:23], 0 offen sc1
    buffer_load_dwordx2 v[122:123], v61, s[20:23], 0 offen sc1
    buffer_load_dwordx2 v[124:125], v62, s[20:23], 0 offen sc1
    s_waitcnt vmcnt(15)
    v_max_u32 v12, v64, v65
    v_max3_u32 v12, v12, v66, v67
    v_max3_u32 v12, v12, v68, v69
    v_max3_u32 v12, v12, v70, v71
    v_max3_u32 v12, v12, v72, v73
    v_max3_u32 v12, v12, v74, v75
    v_max3_u32 v12, v12, v76, v77
    v_max3_u32 v12, v12, v78, v79
    v_max3_u32 v12, v12, v80, v81
    v_max3_u32 v12, v12, v82, v83
    v_max3_u32 v12, v12, v84, v85
    v_max3_u32 v12, v12, v86, v87
    v_max3_u32 v12, v12, v88, v89
    v_max3_u32 v12, v12, v90, v91
    v_max3_u32 v12, v12, v92, v93
    v_cmp_eq_u32 vcc, -1, v12
    s_cmp_lg_u64 vcc, 0
    s_cbranch_scc0 k1_poll_out
    buffer_load_dwordx2 v[64:65], v48, s[20:23], 0 offen sc1
    buffer_load_dwordx2 v[66:67], v49, s[20:23], 0 offen sc1
    buffer_load_dwordx2 v[68:69], v50, s[20:23], 0 offen sc1
    buffer_load_dwordx2 v[70:71], v51, s[20:23], 0 offen sc1
    buffer_load_dwordx2 v[72:73], v52, s[20:23], 0 offen sc1
    buffer_load_dwordx2 v[74:75], v53, s[20:23], 0 offen sc1
    buffer_load_dwordx2 v[76:77], v54, s[20:23], 0 offen sc1
    buffer_load_dwordx2 v[78:79], v55, s[20:23], 0 offen sc1
    buffer_load_dwordx2 v[80:81], v56, s[20:23], 0 offen sc1
    buffer_load_dwordx2 v[82:83], v57, s[20:23], 0 offen sc1
    buffer_load_dwordx2 v[84:85], v58, s[20:23], 0 offen sc1
    buffer_load_dwordx2 v[86:87], v59, s[20:23], 0 offen sc1
    buffer_load_dwordx2 v[88:89], v60, s[20:23], 0 offen sc1
    buffer_load_dwordx2 v[90:91], v61, s[20:23], 0 offen sc1
    buffer_load_dwordx2 v[92:93], v62, s[20:23], 0 offen sc1
    s_waitcnt vmcnt(15)
    v_max_u32 v12, v96, v97
    v_max3_u32 v12, v12, v98, v99
    v_max3_u32 v12, v12, v100, v101
    v_max3_u32 v12, v12, v102, v103
    v_max3_u32 v12, v12, v104, v105
    v_max3_u32 v12, v12, v106, v107
    v_max3_u32 v12, v12, v108, v109
    v_max3_u32 v12, v12, v110, v111
    v_max3_u32 v12, v12, v112, v113
    v_max3_u32 v12, v12, v114, v115
    v_max3_u32 v12, v12, v116, v117
    v_max3_u32 v12, v12, v118, v119
    v_max3_u32 v12, v12, v120, v121
    v_max3_u32 v12, v12, v122, v123
    v_max3_u32 v12, v12, v124, v125
    v_cmp_eq_u32 vcc, -1, v12
    s_cmp_lg_u64 vcc, 0
    s_cbranch_scc1 k1_poll
    v_fma_f32 v14, v26, v110, v108
    v_fma_f32 v20, v26, v124, v122
    v_fma_f32 v15, v26, v111, v109
    v_fma_f32 v21, v26, v125, v123
    v_fma_f32 v14, -v27, v111, v14
    v_fma_f32 v20, -v27, v125, v20
    v_fma_f32 v15, v27, v110, v15
    v_fma_f32 v21, v27, v124, v21
    v_fma_f32 v12, v26, v14, v106
    v_fma_f32 v18, v26, v20, v120
    v_fma_f32 v13, v26, v15, v107
    v_fma_f32 v19, v26, v21, v121
    v_fma_f32 v12, -v27, v15, v12
    v_fma_f32 v18, -v27, v21, v18
    v_fma_f32 v13, v27, v14, v13
    v_fma_f32 v19, v27, v20, v19
    v_fma_f32 v14, v26, v12, v104
    v_fma_f32 v20, v26, v18, v118
    v_fma_f32 v15, v26, v13, v105
    v_fma_f32 v21, v26, v19, v119
    v_fma_f32 v14, -v27, v13, v14
    v_fma_f32 v20, -v27, v19, v20
    v_fma_f32 v15, v27, v12, v15
    v_fma_f32 v21, v27, v18, v21
    v_fma_f32 v12, v26, v14, v102
    v_fma_f32 v18, v26, v20, v116
    v_fma_f32 v13, v26, v15, v103
    v_fma_f32 v19, v26, v21, v117
    v_fma_f32 v12, -v27, v15, v12
    v_fma_f32 v18, -v27, v21, v18
    v_fma_f32 v13, v27, v14, v13
    v_fma_f32 v19, v27, v20, v19
    v_fma_f32 v14, v26, v12, v100
    v_fma_f32 v20, v26, v18, v114
    v_fma_f32 v15, v26, v13, v101
    v_fma_f32 v21, v26, v19, v115
    v_fma_f32 v14, -v27, v13, v14
    v_fma_f32 v20, -v27, v19, v20
    v_fma_f32 v15, v27, v12, v15
    v_fma_f32 v21, v27, v18, v21
    v_fma_f32 v12, v26, v14, v98
    v_fma_f32 v18, v26, v20, v112
    v_fma_f32 v13, v26, v15, v99
    v_fma_f32 v19, v26, v21, v113
    v_fma_f32 v12, -v27, v15, v12
    v_fma_f32 v18, -v27, v21, v18
    v_fma_f32 v13, v27, v14, v13
    v_fma_f32 v19, v27, v20, v19
    v_fma_f32 v14, v26, v12, v96
    v_fma_f32 v15, v26, v13, v97
    v_fma_f32 v14, -v27, v13, v14
    v_fma_f32 v15, v27, v12, v15
    v_fma_f32 v22, v30, v18, v14
    v_fma_f32 v23, v30, v19, v15
    v_fma_f32 v22, -v31, v19, v22
    v_fma_f32 v23, v31, v18, v23
    s_branch k1_poll_done
k1_poll_out:
    v_fma_f32 v14, v26, v78, v76
    v_fma_f32 v20, v26, v92, v90
    v_fma_f32 v15, v26, v79, v77
    v_fma_f32 v21, v26, v93, v91
    v_fma_f32 v14, -v27, v79, v14
    v_fma_f32 v20, -v27, v93, v20
    v_fma_f32 v15, v27, v78, v15
    v_fma_f32 v21, v27, v92, v21
    v_fma_f32 v12, v26, v14, v74
    v_fma_f32 v18, v26, v20, v88
    v_fma_f32 v13, v26, v15, v75
    v_fma_f32 v19, v26, v21, v89
    v_fma_f32 v12, -v27, v15, v12
    v_fma_f32 v18, -v27, v21, v18
    v_fma_f32 v13, v27, v14, v13
    v_fma_f32 v19, v27, v20, v19
    v_fma_f32 v14, v26, v12, v72
    v_fma_f32 v20, v26, v18, v86
    v_fma_f32 v15, v26, v13, v73
    v_fma_f32 v21, v26, v19, v87
    v_fma_f32 v14, -v27, v13, v14
    v_fma_f32 v20, -v27, v19, v20
    v_fma_f32 v15, v27, v12, v15
    v_fma_f32 v21, v27, v18, v21
    v_fma_f32 v12, v26, v14, v70
    v_fma_f32 v18, v26, v20, v84
    v_fma_f32 v13, v26, v15, v71
    v_fma_f32 v19, v26, v21, v85
    v_fma_f32 v12, -v27, v15, v12
    v_fma_f32 v18, -v27, v21, v18
    v_fma_f32 v13, v27, v14, v13
    v_fma_f32 v19, v27, v20, v19
    v_fma_f32 v14, v26, v12, v68
    v_fma_f32 v20, v26, v18, v82
    v_fma_f32 v15, v26, v13, v69
    v_fma_f32 v21, v26, v19, v83
    v_fma_f32 v14, -v27, v13, v14
    v_fma_f32 v20, -v27, v19, v20
    v_fma_f32 v15, v27, v12, v15
    v_fma_f32 v21, v27, v18, v21
    v_fma_f32 v12, v26, v14, v66
    v_fma_f32 v18, v26, v20, v80
    v_fma_f32 v13, v26, v15, v67
    v_fma_f32 v19, v26, v21, v81
    v_fma_f32 v12, -v27, v15, v12
    v_fma_f32 v18, -v27, v21, v18
    v_fma_f32 v13, v27, v14, v13
    v_fma_f32 v19, v27, v20, v19
    v_fma_f32 v14, v26, v12, v64
    v_fma_f32 v15, v26, v13, v65
    v_fma_f32 v14, -v27, v13, v14
    v_fma_f32 v15, v27, v12, v15
    v_fma_f32 v22, v30, v18, v14
    v_fma_f32 v23, v30, v19, v15
    v_fma_f32 v22, -v31, v19, v22
    v_fma_f32 v23, v31, v18, v23
k1_poll_done:
    ds_write_b64 v5, v[22:23] offset:24576
    s_waitcnt lgkmcnt(0)
    s_barrier
    s_waitcnt vmcnt(0)
    s_endpgm
k1_loader_ffn:
    s_mul_i32 s48, s42, 9216
    s_add_u32 s48, s48, 16384
    s_sub_u32 s50, s41, 10
    s_mul_i32 s50, s50, 576
    s_mul_i32 s51, s42, 55296
    s_add_u32 s50, s50, s51
    v_cmp_le_u32 vcc, 36, v1
    v_subrev_u32 v22, 36, v1
    s_nop 0
    v_cndmask_b32 v20, v1, v22, vcc
    v_cndmask_b32 v21, 0, 1, vcc
    v_bfe_u32 v22, v21, 3, 1
    v_lshlrev_b32 v22, 1, v22
    v_xor_b32 v22, v20, v22
    v_mul_u32_u24 v23, 3456, v21
    v_lshl_add_u32 v23, v22, 4, v23
    v_add_u32 v8, s50, v23
    v_add_u32 v20, 28, v20
    v_cmp_le_u32 vcc, 36, v20
    v_subrev_u32 v22, 36, v20
    s_nop 0
    v_cndmask_b32 v20, v20, v22, vcc
    v_addc_co_u32 v21, vcc, 1, v21, vcc
    v_bfe_u32 v22, v21, 3, 1
    v_lshlrev_b32 v22, 1, v22
    v_xor_b32 v22, v20, v22
    v_mul_u32_u24 v23, 3456, v21
    v_lshl_add_u32 v23, v22, 4, v23
    v_add_u32 v9, s50, v23
    s_waitcnt lgkmcnt(0)
    s_mov_b32 s8, s4
    s_mov_b32 s9, s5
    s_mov_b32 s10, 2621440
    s_mov_b32 s11, 0x00020000
    s_mov_b32 s12, s32
    s_mov_b32 s13, s33
    s_mov_b32 s14, 2211840
    s_mov_b32 s15, 0x00020000
    s_add_u32 m0, s47, 0
    s_add_u32 s49, s44, 0
    buffer_load_dwordx4 v4, s[8:11], s49 offen lds
    s_add_u32 m0, s47, 1024
    s_add_u32 s49, s44, 0
    buffer_load_dwordx4 v5, s[8:11], s49 offen lds
    s_add_u32 m0, s47, 2048
    s_add_u32 s49, s44, 0
    buffer_load_dwordx4 v6, s[8:11], s49 offen lds
    s_add_u32 m0, s47, 3072
    s_add_u32 s49, s44, 0
    buffer_load_dwordx4 v7, s[8:11], s49 offen lds
    s_add_u32 m0, s48, 0
    s_mov_b32 s49, 0
    buffer_load_dwordx4 v8, s[12:15], s49 offen lds
    s_add_u32 m0, s48, 1024
    s_mov_b32 s49, 0
    buffer_load_dwordx4 v9, s[12:15], s49 offen lds
    v_add_u32 v20, 28, v20
    v_cmp_le_u32 vcc, 36, v20
    v_subrev_u32 v22, 36, v20
    s_nop 0
    v_cndmask_b32 v20, v20, v22, vcc
    v_addc_co_u32 v21, vcc, 1, v21, vcc
    v_bfe_u32 v22, v21, 3, 1
    v_lshlrev_b32 v22, 1, v22
    v_xor_b32 v22, v20, v22
    v_mul_u32_u24 v23, 3456, v21
    v_lshl_add_u32 v23, v22, 4, v23
    v_add_u32 v10, s50, v23
    s_add_u32 m0, s48, 2048
    s_mov_b32 s49, 0
    buffer_load_dwordx4 v10, s[12:15], s49 offen lds
    v_add_u32 v20, 28, v20
    v_cmp_le_u32 vcc, 36, v20
    v_subrev_u32 v22, 36, v20
    s_nop 0
    v_cndmask_b32 v20, v20, v22, vcc
    v_addc_co_u32 v21, vcc, 1, v21, vcc
    v_bfe_u32 v22, v21, 3, 1
    v_lshlrev_b32 v22, 1, v22
    v_xor_b32 v22, v20, v22
    v_mul_u32_u24 v23, 3456, v21
    v_lshl_add_u32 v23, v22, 4, v23
    v_add_u32 v11, s50, v23
    s_add_u32 m0, s48, 3072
    s_mov_b32 s49, 0
    buffer_load_dwordx4 v11, s[12:15], s49 offen lds
    v_add_u32 v20, 28, v20
    v_cmp_le_u32 vcc, 36, v20
    v_subrev_u32 v22, 36, v20
    s_nop 0
    v_cndmask_b32 v20, v20, v22, vcc
    v_addc_co_u32 v21, vcc, 1, v21, vcc
    v_bfe_u32 v22, v21, 3, 1
    v_lshlrev_b32 v22, 1, v22
    v_xor_b32 v22, v20, v22
    v_mul_u32_u24 v23, 3456, v21
    v_lshl_add_u32 v23, v22, 4, v23
    v_add_u32 v12, s50, v23
    s_add_u32 m0, s48, 4096
    s_mov_b32 s49, 0
    buffer_load_dwordx4 v12, s[12:15], s49 offen lds
    v_add_u32 v20, 28, v20
    v_cmp_le_u32 vcc, 36, v20
    v_subrev_u32 v22, 36, v20
    s_nop 0
    v_cndmask_b32 v20, v20, v22, vcc
    v_addc_co_u32 v21, vcc, 1, v21, vcc
    v_bfe_u32 v22, v21, 3, 1
    v_lshlrev_b32 v22, 1, v22
    v_xor_b32 v22, v20, v22
    v_mul_u32_u24 v23, 3456, v21
    v_lshl_add_u32 v23, v22, 4, v23
    v_add_u32 v13, s50, v23
    s_add_u32 m0, s48, 5120
    s_mov_b32 s49, 0
    buffer_load_dwordx4 v13, s[12:15], s49 offen lds
    v_add_u32 v20, 28, v20
    v_cmp_le_u32 vcc, 36, v20
    v_subrev_u32 v22, 36, v20
    s_nop 0
    v_cndmask_b32 v20, v20, v22, vcc
    v_addc_co_u32 v21, vcc, 1, v21, vcc
    v_bfe_u32 v22, v21, 3, 1
    v_lshlrev_b32 v22, 1, v22
    v_xor_b32 v22, v20, v22
    v_mul_u32_u24 v23, 3456, v21
    v_lshl_add_u32 v23, v22, 4, v23
    v_add_u32 v14, s50, v23
    s_add_u32 m0, s48, 6144
    s_mov_b32 s49, 0
    buffer_load_dwordx4 v14, s[12:15], s49 offen lds
    v_add_u32 v20, 28, v20
    v_cmp_le_u32 vcc, 36, v20
    v_subrev_u32 v22, 36, v20
    s_nop 0
    v_cndmask_b32 v20, v20, v22, vcc
    v_addc_co_u32 v21, vcc, 1, v21, vcc
    v_bfe_u32 v22, v21, 3, 1
    v_lshlrev_b32 v22, 1, v22
    v_xor_b32 v22, v20, v22
    v_mul_u32_u24 v23, 3456, v21
    v_lshl_add_u32 v23, v22, 4, v23
    v_add_u32 v15, s50, v23
    s_add_u32 m0, s48, 7168
    s_mov_b32 s49, 0
    buffer_load_dwordx4 v15, s[12:15], s49 offen lds
    v_add_u32 v20, 28, v20
    v_cmp_le_u32 vcc, 36, v20
    v_subrev_u32 v22, 36, v20
    s_nop 0
    v_cndmask_b32 v20, v20, v22, vcc
    v_addc_co_u32 v21, vcc, 1, v21, vcc
    v_bfe_u32 v22, v21, 3, 1
    v_lshlrev_b32 v22, 1, v22
    v_xor_b32 v22, v20, v22
    v_mul_u32_u24 v23, 3456, v21
    v_lshl_add_u32 v23, v22, 4, v23
    v_add_u32 v16, s50, v23
    s_add_u32 m0, s48, 8192
    s_mov_b32 s49, 0
    buffer_load_dwordx4 v16, s[12:15], s49 offen lds
    s_add_u32 m0, s47, 53248
    s_add_u32 s49, s44, 16384
    buffer_load_dwordx4 v4, s[8:11], s49 offen lds
    s_add_u32 m0, s47, 54272
    s_add_u32 s49, s44, 16384
    buffer_load_dwordx4 v5, s[8:11], s49 offen lds
    s_add_u32 m0, s47, 55296
    s_add_u32 s49, s44, 16384
    buffer_load_dwordx4 v6, s[8:11], s49 offen lds
    s_add_u32 m0, s47, 56320
    s_add_u32 s49, s44, 16384
    buffer_load_dwordx4 v7, s[8:11], s49 offen lds
    s_add_u32 m0, s48, 53248
    s_mov_b32 s49, 221184
    buffer_load_dwordx4 v8, s[12:15], s49 offen lds
    s_add_u32 m0, s48, 54272
    s_mov_b32 s49, 221184
    buffer_load_dwordx4 v9, s[12:15], s49 offen lds
    s_add_u32 m0, s48, 55296
    s_mov_b32 s49, 221184
    buffer_load_dwordx4 v10, s[12:15], s49 offen lds
    s_waitcnt vmcnt(7)
    s_barrier
    s_add_u32 m0, s48, 56320
    s_mov_b32 s49, 221184
    buffer_load_dwordx4 v11, s[12:15], s49 offen lds
    s_add_u32 m0, s48, 57344
    s_mov_b32 s49, 221184
    buffer_load_dwordx4 v12, s[12:15], s49 offen lds
    s_add_u32 m0, s48, 58368
    s_mov_b32 s49, 221184
    buffer_load_dwordx4 v13, s[12:15], s49 offen lds
    s_add_u32 m0, s48, 59392
    s_mov_b32 s49, 221184
    buffer_load_dwordx4 v14, s[12:15], s49 offen lds
    s_add_u32 m0, s48, 60416
    s_mov_b32 s49, 221184
    buffer_load_dwordx4 v15, s[12:15], s49 offen lds
    s_add_u32 m0, s48, 61440
    s_mov_b32 s49, 221184
    buffer_load_dwordx4 v16, s[12:15], s49 offen lds
    s_add_u32 s44, s44, 32768
    s_mov_b32 s45, 442368
    s_mov_b32 s43, 106496
    s_setprio 0
    s_mov_b32 s51, 1
k1f_ld_loop:
    s_add_u32 s49, s43, s47
    s_add_u32 m0, s49, 0
    s_nop 0
    buffer_load_dwordx4 v4, s[8:11], s44 offen lds
    s_add_u32 m0, s49, 1024
    s_nop 0
    buffer_load_dwordx4 v5, s[8:11], s44 offen lds
    s_add_u32 m0, s49, 2048
    s_nop 0
    buffer_load_dwordx4 v6, s[8:11], s44 offen lds
    s_add_u32 m0, s49, 3072
    s_nop 0
    buffer_load_dwordx4 v7, s[8:11], s44 offen lds
    s_add_u32 s49, s43, s48
    s_add_u32 m0, s49, 0
    s_nop 0
    buffer_load_dwordx4 v8, s[12:15], s45 offen lds
    s_add_u32 m0, s49, 1024
    s_nop 0
    buffer_load_dwordx4 v9, s[12:15], s45 offen lds
    s_add_u32 m0, s49, 2048
    s_nop 0
    buffer_load_dwordx4 v10, s[12:15], s45 offen lds
    s_add_u32 m0, s49, 3072
    s_nop 0
    buffer_load_dwordx4 v11, s[12:15], s45 offen lds
    s_add_u32 m0, s49, 4096
    s_nop 0
    buffer_load_dwordx4 v12, s[12:15], s45 offen lds
    s_add_u32 m0, s49, 5120
    s_nop 0
    buffer_load_dwordx4 v13, s[12:15], s45 offen lds
    s_add_u32 m0, s49, 6144
    s_nop 0
    buffer_load_dwordx4 v14, s[12:15], s45 offen lds
    s_add_u32 m0, s49, 7168
    s_nop 0
    buffer_load_dwordx4 v15, s[12:15], s45 offen lds
    s_add_u32 m0, s49, 8192
    s_nop 0
    buffer_load_dwordx4 v16, s[12:15], s45 offen lds
    s_add_u32 s44, s44, 16384
    s_add_u32 s45, s45, 221184
    s_add_u32 s43, s43, 53248
    s_cmp_eq_u32 s43, 159744
    s_cselect_b32 s43, 0, s43
    s_waitcnt vmcnt(13)
    s_barrier
    s_add_u32 s51, s51, 1
    s_cmp_le_u32 s51, 8
    s_cbranch_scc1 k1f_ld_loop
    s_waitcnt vmcnt(0)
    s_barrier
    s_barrier
    s_endpgm
k1_pack:
    s_lshl_b32 s34, s41, 4
    s_add_u32 s34, s34, s40
    s_sub_u32 s35, s42, 2
    s_mul_i32 s35, s35, 5
    s_lshl_b32 s49, s35, 3
    v_add_u32 v20, s49, v2
    v_add_u32 v20, 0, v20
    v_bfe_u32 v21, v20, 1, 3
    v_xor_b32 v21, v21, v3
    v_mul_u32_u24 v20, 1280, v20
    v_lshl_add_u32 v4, v21, 4, v20
    v_add_u32 v20, s49, v2
    v_add_u32 v20, 8, v20
    v_bfe_u32 v21, v20, 1, 3
    v_xor_b32 v21, v21, v3
    v_mul_u32_u24 v20, 1280, v20
    v_lshl_add_u32 v5, v21, 4, v20
    v_add_u32 v20, s49, v2
    v_add_u32 v20, 16, v20
    v_bfe_u32 v21, v20, 1, 3
    v_xor_b32 v21, v21, v3
    v_mul_u32_u24 v20, 1280, v20
    v_lshl_add_u32 v6, v21, 4, v20
    v_add_u32 v20, s49, v2
    v_add_u32 v20, 24, v20
    v_bfe_u32 v21, v20, 1, 3
    v_xor_b32 v21, v21, v3
    v_mul_u32_u24 v20, 1280, v20
    v_lshl_add_u32 v7, v21, 4, v20
    v_add_u32 v20, s49, v2
    v_add_u32 v20, 32, v20
    v_bfe_u32 v21, v20, 1, 3
    v_xor_b32 v21, v21, v3
    v_mul_u32_u24 v20, 1280, v20
    v_lshl_add_u32 v8, v21, 4, v20
    s_lshl_b32 s49, s35, 6
    v_add_u32 v20, s49, v1
    v_add_u32 v20, 0, v20
    v_mul_u32_u24 v21, 6554, v20
    v_lshrrev_b32 v21, 16, v21
    v_mul_u32_u24 v22, 10, v21
    v_sub_u32 v20, v20, v22
    v_and_b32 v22, 0xfffffff3, v21
    v_bfe_u32 v23, v21, 2, 1
    v_lshl_add_u32 v22, v23, 3, v22
    v_bfe_u32 v23, v21, 3, 1
    v_lshl_add_u32 v22, v23, 2, v22
    v_mul_u32_u24 v22, 1280, v22
    v_lshl_add_u32 v10, v20, 4, v22
    v_add_u32 v20, s49, v1
    v_add_u32 v20, 64, v20
    v_mul_u32_u24 v21, 6554, v20
    v_lshrrev_b32 v21, 16, v21
    v_mul_u32_u24 v22, 10, v21
    v_sub_u32 v20, v20, v22
    v_and_b32 v22, 0xfffffff3, v21
    v_bfe_u32 v23, v21, 2, 1
    v_lshl_add_u32 v22, v23, 3, v22
    v_bfe_u32 v23, v21, 3, 1
    v_lshl_add_u32 v22, v23, 2, v22
    v_mul_u32_u24 v22, 1280, v22
    v_lshl_add_u32 v11, v20, 4, v22
    v_add_u32 v20, s49, v1
    v_add_u32 v20, 128, v20
    v_mul_u32_u24 v21, 6554, v20
    v_lshrrev_b32 v21, 16, v21
    v_mul_u32_u24 v22, 10, v21
    v_sub_u32 v20, v20, v22
    v_and_b32 v22, 0xfffffff3, v21
    v_bfe_u32 v23, v21, 2, 1
    v_lshl_add_u32 v22, v23, 3, v22
    v_bfe_u32 v23, v21, 3, 1
    v_lshl_add_u32 v22, v23, 2, v22
    v_mul_u32_u24 v22, 1280, v22
    v_lshl_add_u32 v12, v20, 4, v22
    v_add_u32 v20, s49, v1
    v_add_u32 v20, 192, v20
    v_mul_u32_u24 v21, 6554, v20
    v_lshrrev_b32 v21, 16, v21
    v_mul_u32_u24 v22, 10, v21
    v_sub_u32 v20, v20, v22
    v_and_b32 v22, 0xfffffff3, v21
    v_bfe_u32 v23, v21, 2, 1
    v_lshl_add_u32 v22, v23, 3, v22
    v_bfe_u32 v23, v21, 3, 1
    v_lshl_add_u32 v22, v23, 2, v22
    v_mul_u32_u24 v22, 1280, v22
    v_lshl_add_u32 v13, v20, 4, v22
    v_add_u32 v20, s49, v1
    v_add_u32 v20, 256, v20
    v_mul_u32_u24 v21, 6554, v20
    v_lshrrev_b32 v21, 16, v21
    v_mul_u32_u24 v22, 10, v21
    v_sub_u32 v20, v20, v22
    v_and_b32 v22, 0xfffffff3, v21
    v_bfe_u32 v23, v21, 2, 1
    v_lshl_add_u32 v22, v23, 3, v22
    v_bfe_u32 v23, v21, 3, 1
    v_lshl_add_u32 v22, v23, 2, v22
    v_mul_u32_u24 v22, 1280, v22
    v_lshl_add_u32 v14, v20, 4, v22
    v_lshlrev_b32 v16, 4, v1
    s_lshl_b32 s49, s35, 10
    v_add_u32 v16, s49, v16
    v_add_u32 v17, 4096, v16
    s_add_u32 s16, s4, 15093760
    s_addc_u32 s17, s5, 0
    s_mov_b32 s18, 3850240
    s_mov_b32 s19, 0x00020000
    s_mov_b32 s24, s60
    s_mov_b32 s25, s61
    s_mov_b32 s26, 2211840
    s_mov_b32 s27, 0x00020000
    s_mul_i32 s49, s34, 3277
    s_lshr_b32 s49, s49, 16
    s_mul_i32 s50, s49, 20
    s_sub_u32 s50, s34, s50
    s_mul_i32 s36, s49, 47
    s_add_u32 s36, s36, s50
    s_cmp_ge_u32 s50, 10
    s_cselect_b32 s12, s58, s56
    s_cselect_b32 s13, s59, s57
    s_cselect_b32 s39, 10, 0
    s_sub_u32 s50, s50, s39
    s_lshl_b32 s50, s50, 7
    s_mul_i32 s49, s49, 102400
    s_add_u32 s49, s49, s50
    s_mov_b32 s14, 819200
    s_mov_b32 s15, 0x00020000
    buffer_load_dwordx4 v[32:35], v4, s[12:15], s49 offen
    buffer_load_dwordx4 v[36:39], v5, s[12:15], s49 offen
    buffer_load_dwordx4 v[40:43], v6, s[12:15], s49 offen
    buffer_load_dwordx4 v[44:47], v7, s[12:15], s49 offen
    buffer_load_dwordx4 v[48:51], v8, s[12:15], s49 offen
    s_mul_i32 s49, s34, 2428
    s_lshr_b32 s49, s49, 16
    s_mul_i32 s50, s49, 27
    s_sub_u32 s50, s34, s50
    s_mul_i32 s37, s49, 47
    s_add_u32 s37, s37, s50
    s_add_u32 s37, s37, 20
    s_mul_i32 s50, s50, 81920
    s_mul_i32 s49, s49, 160
    s_add_u32 s49, s49, s50
    buffer_load_dwordx4 v[52:55], v10, s[24:27], s49 offen
    buffer_load_dwordx4 v[56:59], v11, s[24:27], s49 offen
    buffer_load_dwordx4 v[60:63], v12, s[24:27], s49 offen
    buffer_load_dwordx4 v[64:67], v13, s[24:27], s49 offen
    buffer_load_dwordx4 v[68:71], v14, s[24:27], s49 offen
    s_add_u32 s62, s34, 160
    s_min_u32 s62, s62, 215
    s_mul_i32 s49, s62, 2428
    s_lshr_b32 s49, s49, 16
    s_mul_i32 s50, s49, 27
    s_sub_u32 s50, s62, s50
    s_mul_i32 s38, s49, 47
    s_add_u32 s38, s38, s50
    s_add_u32 s38, s38, 20
    s_mul_i32 s50, s50, 81920
    s_mul_i32 s49, s49, 160
    s_add_u32 s49, s49, s50
    buffer_load_dwordx4 v[72:75], v10, s[24:27], s49 offen
    buffer_load_dwordx4 v[76:79], v11, s[24:27], s49 offen
    buffer_load_dwordx4 v[80:83], v12, s[24:27], s49 offen
    buffer_load_dwordx4 v[84:87], v13, s[24:27], s49 offen
    buffer_load_dwordx4 v[88:91], v14, s[24:27], s49 offen
    s_waitcnt vmcnt(31)
    s_barrier
    s_waitcnt vmcnt(23)
    s_barrier
    s_waitcnt vmcnt(15)
    s_barrier
    s_barrier
    s_waitcnt vmcnt(0)
    s_mul_i32 s49, s36, 10240
    buffer_store_dwordx4 v[32:35], v16, s[16:19], s49 offen offset:0 sc1
    buffer_store_dwordx4 v[36:39], v16, s[16:19], s49 offen offset:1024 sc1
    buffer_store_dwordx4 v[40:43], v16, s[16:19], s49 offen offset:2048 sc1
    buffer_store_dwordx4 v[44:47], v16, s[16:19], s49 offen offset:3072 sc1
    buffer_store_dwordx4 v[48:51], v17, s[16:19], s49 offen offset:0 sc1
    s_mul_i32 s49, s37, 10240
    buffer_store_dwordx4 v[52:55], v16, s[16:19], s49 offen offset:0 sc1
    buffer_store_dwordx4 v[56:59], v16, s[16:19], s49 offen offset:1024 sc1
    buffer_store_dwordx4 v[60:63], v16, s[16:19], s49 offen offset:2048 sc1
    buffer_store_dwordx4 v[64:67], v16, s[16:19], s49 offen offset:3072 sc1
    buffer_store_dwordx4 v[68:71], v17, s[16:19], s49 offen offset:0 sc1
    s_cmp_lt_u32 s34, 56
    s_cbranch_scc0 k1_pack_nox2
    s_mul_i32 s49, s38, 10240
    buffer_store_dwordx4 v[72:75], v16, s[16:19], s49 offen offset:0 sc1
    buffer_store_dwordx4 v[76:79], v16, s[16:19], s49 offen offset:1024 sc1
    buffer_store_dwordx4 v[80:83], v16, s[16:19], s49 offen offset:2048 sc1
    buffer_store_dwordx4 v[84:87], v16, s[16:19], s49 offen offset:3072 sc1
    buffer_store_dwordx4 v[88:91], v17, s[16:19], s49 offen offset:0 sc1
k1_pack_nox2:
    s_endpgm
k1_done:
    s_endpgm
.globl k2_kernel
.p2align 8
.type k2_kernel,@function
k2_kernel:
    s_cmp_ge_u32 s2, 256
    s_cbranch_scc1 k2_done
    s_load_dwordx2 s[4:5], s[0:1], 112
    s_load_dwordx2 s[36:37], s[0:1], 0
    s_load_dwordx2 s[30:31], s[0:1], 96
    s_load_dwordx2 s[38:39], s[0:1], 64
    v_lshrrev_b32 v1, 6, v0
    s_and_b32 s50, s2, 7
    s_lshr_b32 s51, s2, 3
    v_readfirstlane_b32 s42, v1
    s_lshr_b32 s40, s50, 1
    s_lshl_b32 s40, s40, 3
    s_and_b32 s41, s51, 7
    s_add_u32 s40, s40, s41
    s_and_b32 s41, s50, 1
    s_lshl_b32 s41, s41, 2
    s_lshr_b32 s51, s51, 3
    s_add_u32 s41, s41, s51
    s_cmp_ge_u32 s42, 4
    s_cbranch_scc1 k2_loader
    s_and_b32 s54, s42, 1
    s_lshr_b32 s55, s42, 1
    v_and_b32 v1, 63, v0
    v_lshrrev_b32 v14, 4, v1
    v_and_b32 v15, 15, v1
    v_bfe_u32 v16, v1, 2, 2
    v_and_b32 v17, 3, v1
    s_lshl_b32 s50, s55, 12
    v_lshl_add_u32 v18, v14, 3, v16
    v_lshlrev_b32 v18, 7, v18
    v_lshl_add_u32 v18, v17, 3, v18
    v_add_u32 v18, s50, v18
    v_lshrrev_b32 v19, 1, v16
    v_and_b32 v20, 1, v14
    v_lshl_add_u32 v19, v20, 1, v19
    s_lshl_b32 s50, s54, 1
    v_xor_b32 v19, s50, v19
    v_lshl_add_u32 v2, v19, 5, v18
    v_xor_b32 v19, 1, v19
    v_lshl_add_u32 v3, v19, 5, v18
    v_lshrrev_b32 v18, 1, v15
    s_lshl_b32 s50, s55, 2
    v_add_u32 v19, s50, v14
    v_xor_b32 v18, v18, v19
    v_lshlrev_b32 v18, 4, v18
    v_lshl_add_u32 v18, v15, 7, v18
    v_add_u32 v4, 8192, v18
    v_lshrrev_b32 v18, 1, v14
    v_lshlrev_b32 v18, 4, v18
    v_and_b32 v19, 1, v14
    v_lshl_add_u32 v18, v19, 2, v18
    v_add_u32 v18, v18, v16
    s_lshl_b32 s50, s55, 5
    v_add_u32 v18, s50, v18
    v_mul_u32_u24 v18, 160, v18
    v_lshl_add_u32 v18, v17, 3, v18
    v_add_u32 v5, 8192, v18
    s_lshl_b32 s50, s55, 5
    s_lshl_b32 s51, s54, 3
    s_add_u32 s50, s50, s51
    v_lshrrev_b32 v22, 3, v15
    v_lshlrev_b32 v22, 4, v22
    v_and_b32 v23, 7, v15
    v_add_u32 v22, v22, v23
    v_add_u32 v22, s50, v22
    v_mul_u32_u24 v24, 160, v22
    v_lshl_add_u32 v24, v14, 3, v24
    v_add_u32 v24, 129024, v24
    s_lshl_b32 s50, s40, 6
    v_add_u32 v22, s50, v22
    v_lshlrev_b32 v28, 3, v22
    v_mul_u32_u24 v22, 640, v22
    s_mul_i32 s50, s41, 80
    v_lshlrev_b32 v29, 2, v14
    v_add_u32 v29, s50, v29
    v_lshlrev_b32 v29, 1, v29
    v_lshl_add_u32 v22, v14, 2, v22
    v_add_u32 v22, s50, v22
    v_lshlrev_b32 v25, 2, v22
    s_mul_i32 s50, s42, 10240
    v_lshlrev_b32 v20, 4, v1
    v_add_u32 v20, s50, v20
    s_xor_b32 s51, s42, 2
    s_mul_i32 s51, s51, 10240
    v_lshlrev_b32 v21, 4, v1
    v_add_u32 v21, s51, v21
    s_mul_i32 s50, s42, 5120
    s_add_u32 s50, s50, 139264
    v_lshlrev_b32 v26, 4, v1
    v_add_u32 v26, s50, v26
    s_xor_b32 s51, s42, 2
    s_mul_i32 s51, s51, 5120
    s_add_u32 s51, s51, 139264
    v_lshlrev_b32 v27, 4, v1
    v_add_u32 v27, s51, v27
    s_waitcnt lgkmcnt(0)
    s_mov_b32 s12, s30
    s_mov_b32 s13, s31
    s_mov_b32 s14, 5242880
    s_mov_b32 s15, 0x00020000
    s_add_u32 s8, s4, 15060992
    s_addc_u32 s9, s5, 0
    s_mov_b32 s10, 32768
    s_mov_b32 s11, 0x00020000
    s_mul_i32 s50, s42, 3
    s_lshl_b32 s51, s42, 1
    s_add_u32 s51, s51, 2
    s_cmp_ge_u32 s42, 2
    s_cselect_b32 s56, s51, s50
    s_lshl_b32 s50, s56, 6
    s_mul_i32 s51, s40, 81920
    s_mul_i32 s58, s41, 160
    s_add_u32 s51, s51, s58
    v_add_u32 v168, s50, v1
    v_add_u32 v168, 0, v168
    v_mul_u32_u24 v169, 6554, v168
    v_lshrrev_b32 v169, 16, v169
    v_mul_u32_u24 v170, 10, v169
    v_sub_u32 v168, v168, v170
    v_mul_u32_u24 v169, 1280, v169
    v_lshl_add_u32 v169, v168, 4, v169
    v_add_u32 v190, s51, v169
    v_add_u32 v168, s50, v1
    v_add_u32 v168, 64, v168
    v_mul_u32_u24 v169, 6554, v168
    v_lshrrev_b32 v169, 16, v169
    v_mul_u32_u24 v170, 10, v169
    v_sub_u32 v168, v168, v170
    v_mul_u32_u24 v169, 1280, v169
    v_lshl_add_u32 v169, v168, 4, v169
    v_add_u32 v191, s51, v169
    v_add_u32 v168, s50, v1
    v_add_u32 v168, 128, v168
    v_mul_u32_u24 v169, 6554, v168
    v_lshrrev_b32 v169, 16, v169
    v_mul_u32_u24 v170, 10, v169
    v_sub_u32 v168, v168, v170
    v_mul_u32_u24 v169, 1280, v169
    v_lshl_add_u32 v169, v168, 4, v169
    v_add_u32 v192, s51, v169
    s_mov_b32 s16, s36
    s_mov_b32 s17, s37
    s_mov_b32 s18, 2621440
    s_mov_b32 s19, 0x00020000
    s_add_u32 s20, s4, 2621440
    s_addc_u32 s21, s5, 0
    s_mov_b32 s22, 16384
    s_mov_b32 s23, 0x00020000
    s_mov_b32 s24, s38
    s_mov_b32 s25, s39
    s_mov_b32 s26, 1280
    s_mov_b32 s27, 0x00020000
    v_mov_b32 v32, 0
    v_mov_b32 v33, 0
    v_mov_b32 v34, 0
    v_mov_b32 v35, 0
    v_mov_b32 v36, 0
    v_mov_b32 v37, 0
    v_mov_b32 v38, 0
    v_mov_b32 v39, 0
    v_mov_b32 v40, 0
    v_mov_b32 v41, 0
    v_mov_b32 v42, 0
    v_mov_b32 v43, 0
    v_mov_b32 v44, 0
    v_mov_b32 v45, 0
    v_mov_b32 v46, 0
    v_mov_b32 v47, 0
    v_mov_b32 v48, 0
    v_mov_b32 v49, 0
    v_mov_b32 v50, 0
    v_mov_b32 v51, 0
    v_mov_b32 v52, 0
    v_mov_b32 v53, 0
    v_mov_b32 v54, 0
    v_mov_b32 v55, 0
    v_mov_b32 v56, 0
    v_mov_b32 v57, 0
    v_mov_b32 v58, 0
    v_mov_b32 v59, 0
    v_mov_b32 v60, 0
    v_mov_b32 v61, 0
    v_mov_b32 v62, 0
    v_mov_b32 v63, 0
    v_mov_b32 v64, 0
    v_mov_b32 v65, 0
    v_mov_b32 v66, 0
    v_mov_b32 v67, 0
    v_mov_b32 v68, 0
    v_mov_b32 v69, 0
    v_mov_b32 v70, 0
    v_mov_b32 v71, 0
    v_mov_b32 v72, 0
    v_mov_b32 v73, 0
    v_mov_b32 v74, 0
    v_mov_b32 v75, 0
    v_mov_b32 v76, 0
    v_mov_b32 v77, 0
    v_mov_b32 v78, 0
    v_mov_b32 v79, 0
    v_mov_b32 v80, 0
    v_mov_b32 v81, 0
    v_mov_b32 v82, 0
    v_mov_b32 v83, 0
    v_mov_b32 v84, 0
    v_mov_b32 v85, 0
    v_mov_b32 v86, 0
    v_mov_b32 v87, 0
    v_mov_b32 v88, 0
    v_mov_b32 v89, 0
    v_mov_b32 v90, 0
    v_mov_b32 v91, 0
    v_mov_b32 v92, 0
    v_mov_b32 v93, 0
    v_mov_b32 v94, 0
    v_mov_b32 v95, 0
    v_mov_b32 v96, 0
    v_mov_b32 v97, 0
    v_mov_b32 v98, 0
    v_mov_b32 v99, 0
    v_mov_b32 v100, 0
    v_mov_b32 v101, 0
    v_mov_b32 v102, 0
    v_mov_b32 v103, 0
    v_mov_b32 v104, 0
    v_mov_b32 v105, 0
    v_mov_b32 v106, 0
    v_mov_b32 v107, 0
    v_mov_b32 v108, 0
    v_mov_b32 v109, 0
    v_mov_b32 v110, 0
    v_mov_b32 v111, 0
    s_mov_b32 s44, 0
    v_add_u32 v8, s44, v2
    v_add_u32 v9, s44, v3
    v_add_u32 v10, s44, v4
    s_barrier
    ds_read_b64_tr_b16 v[132:133], v8 offset:0
    ds_read_b64_tr_b16 v[134:135], v8 offset:512
    ds_read_b64_tr_b16 v[136:137], v9 offset:0
    ds_read_b64_tr_b16 v[138:139], v9 offset:512
    ds_read_b128 v[112:115], v10 offset:0
    ds_read_b128 v[116:119], v10 offset:2048
    ds_read_b128 v[120:123], v10 offset:4096
    ds_read_b128 v[124:127], v10 offset:6144
    ds_read_b128 v[128:131], v10 offset:8192
    s_add_u32 s44, s44, 18432
    s_cmp_eq_u32 s44, 129024
    s_cselect_b32 s44, 0, s44
    v_add_u32 v8, s44, v2
    v_add_u32 v9, s44, v3
    v_add_u32 v10, s44, v4
    s_waitcnt lgkmcnt(0)
    v_mfma_f32_16x16x32_bf16 v[32:35], v[112:115], v[132:135], v[32:35]
    s_barrier
    ds_read_b64_tr_b16 v[160:161], v8 offset:0
    ds_read_b64_tr_b16 v[162:163], v8 offset:512
    ds_read_b64_tr_b16 v[164:165], v9 offset:0
    v_mfma_f32_16x16x32_bf16 v[36:39], v[112:115], v[136:139], v[36:39]
    ds_read_b64_tr_b16 v[166:167], v9 offset:512
    ds_read_b128 v[140:143], v10 offset:0
    ds_read_b128 v[144:147], v10 offset:2048
    v_mfma_f32_16x16x32_bf16 v[40:43], v[116:119], v[132:135], v[40:43]
    ds_read_b128 v[148:151], v10 offset:4096
    ds_read_b128 v[152:155], v10 offset:6144
    ds_read_b128 v[156:159], v10 offset:8192
    v_mfma_f32_16x16x32_bf16 v[44:47], v[116:119], v[136:139], v[44:47]
    v_mfma_f32_16x16x32_bf16 v[48:51], v[120:123], v[132:135], v[48:51]
    v_mfma_f32_16x16x32_bf16 v[52:55], v[120:123], v[136:139], v[52:55]
    v_mfma_f32_16x16x32_bf16 v[56:59], v[124:127], v[132:135], v[56:59]
    v_mfma_f32_16x16x32_bf16 v[60:63], v[124:127], v[136:139], v[60:63]
    v_mfma_f32_16x16x32_bf16 v[64:67], v[128:131], v[132:135], v[64:67]
    v_mfma_f32_16x16x32_bf16 v[68:71], v[128:131], v[136:139], v[68:71]
    s_add_u32 s44, s44, 18432
    s_cmp_eq_u32 s44, 129024
    s_cselect_b32 s44, 0, s44
    v_add_u32 v8, s44, v2
    v_add_u32 v9, s44, v3
    v_add_u32 v10, s44, v4
    s_waitcnt lgkmcnt(0)
    v_mfma_f32_16x16x32_bf16 v[32:35], v[140:143], v[160:163], v[32:35]
    s_barrier
    ds_read_b64_tr_b16 v[132:133], v8 offset:0
    ds_read_b64_tr_b16 v[134:135], v8 offset:512
    ds_read_b64_tr_b16 v[136:137], v9 offset:0
    v_mfma_f32_16x16x32_bf16 v[36:39], v[140:143], v[164:167], v[36:39]
    ds_read_b64_tr_b16 v[138:139], v9 offset:512
    ds_read_b128 v[112:115], v10 offset:0
    ds_read_b128 v[116:119], v10 offset:2048
    v_mfma_f32_16x16x32_bf16 v[40:43], v[144:147], v[160:163], v[40:43]
    ds_read_b128 v[120:123], v10 offset:4096
    ds_read_b128 v[124:127], v10 offset:6144
    ds_read_b128 v[128:131], v10 offset:8192
    v_mfma_f32_16x16x32_bf16 v[44:47], v[144:147], v[164:167], v[44:47]
    v_mfma_f32_16x16x32_bf16 v[48:51], v[148:151], v[160:163], v[48:51]
    v_mfma_f32_16x16x32_bf16 v[52:55], v[148:151], v[164:167], v[52:55]
    v_mfma_f32_16x16x32_bf16 v[56:59], v[152:155], v[160:163], v[56:59]
    v_mfma_f32_16x16x32_bf16 v[60:63], v[152:155], v[164:167], v[60:63]
    v_mfma_f32_16x16x32_bf16 v[64:67], v[156:159], v[160:163], v[64:67]
    v_mfma_f32_16x16x32_bf16 v[68:71], v[156:159], v[164:167], v[68:71]
    s_add_u32 s44, s44, 18432
    s_cmp_eq_u32 s44, 129024
    s_cselect_b32 s44, 0, s44
    v_add_u32 v8, s44, v2
    v_add_u32 v9, s44, v3
    v_add_u32 v10, s44, v4
    s_waitcnt lgkmcnt(0)
    v_mfma_f32_16x16x32_bf16 v[32:35], v[112:115], v[132:135], v[32:35]
    s_barrier
    ds_read_b64_tr_b16 v[160:161], v8 offset:0
    ds_read_b64_tr_b16 v[162:163], v8 offset:512
    ds_read_b64_tr_b16 v[164:165], v9 offset:0
    v_mfma_f32_16x16x32_bf16 v[36:39], v[112:115], v[136:139], v[36:39]
    ds_read_b64_tr_b16 v[166:167], v9 offset:512
    ds_read_b128 v[140:143], v10 offset:0
    ds_read_b128 v[144:147], v10 offset:2048
    v_mfma_f32_16x16x32_bf16 v[40:43], v[116:119], v[132:135], v[40:43]
    ds_read_b128 v[148:151], v10 offset:4096
    ds_read_b128 v[152:155], v10 offset:6144
    ds_read_b128 v[156:159], v10 offset:8192
    v_mfma_f32_16x16x32_bf16 v[44:47], v[116:119], v[136:139], v[44:47]
    v_mfma_f32_16x16x32_bf16 v[48:51], v[120:123], v[132:135], v[48:51]
    v_mfma_f32_16x16x32_bf16 v[52:55], v[120:123], v[136:139], v[52:55]
    v_mfma_f32_16x16x32_bf16 v[56:59], v[124:127], v[132:135], v[56:59]
    v_mfma_f32_16x16x32_bf16 v[60:63], v[124:127], v[136:139], v[60:63]
    v_mfma_f32_16x16x32_bf16 v[64:67], v[128:131], v[132:135], v[64:67]
    v_mfma_f32_16x16x32_bf16 v[68:71], v[128:131], v[136:139], v[68:71]
    s_add_u32 s44, s44, 18432
    s_cmp_eq_u32 s44, 129024
    s_cselect_b32 s44, 0, s44
    v_add_u32 v8, s44, v2
    v_add_u32 v9, s44, v3
    v_add_u32 v10, s44, v4
    s_waitcnt lgkmcnt(0)
    v_mfma_f32_16x16x32_bf16 v[32:35], v[140:143], v[160:163], v[32:35]
    s_barrier
    ds_read_b64_tr_b16 v[132:133], v8 offset:0
    ds_read_b64_tr_b16 v[134:135], v8 offset:512
    ds_read_b64_tr_b16 v[136:137], v9 offset:0
    v_mfma_f32_16x16x32_bf16 v[36:39], v[140:143], v[164:167], v[36:39]
    ds_read_b64_tr_b16 v[138:139], v9 offset:512
    ds_read_b128 v[112:115], v10 offset:0
    ds_read_b128 v[116:119], v10 offset:2048
    v_mfma_f32_16x16x32_bf16 v[40:43], v[144:147], v[160:163], v[40:43]
    ds_read_b128 v[120:123], v10 offset:4096
    ds_read_b128 v[124:127], v10 offset:6144
    ds_read_b128 v[128:131], v10 offset:8192
    v_mfma_f32_16x16x32_bf16 v[44:47], v[144:147], v[164:167], v[44:47]
    v_mfma_f32_16x16x32_bf16 v[48:51], v[148:151], v[160:163], v[48:51]
    v_mfma_f32_16x16x32_bf16 v[52:55], v[148:151], v[164:167], v[52:55]
    v_mfma_f32_16x16x32_bf16 v[56:59], v[152:155], v[160:163], v[56:59]
    v_mfma_f32_16x16x32_bf16 v[60:63], v[152:155], v[164:167], v[60:63]
    v_mfma_f32_16x16x32_bf16 v[64:67], v[156:159], v[160:163], v[64:67]
    v_mfma_f32_16x16x32_bf16 v[68:71], v[156:159], v[164:167], v[68:71]
    s_lshl_b32 s50, s56, 10
    s_add_u32 s50, s50, 129024
    s_add_u32 m0, s50, 0
    s_nop 0
    buffer_load_dwordx4 v190, s[16:19], 0 offen lds
    s_add_u32 m0, s50, 1024
    s_nop 0
    buffer_load_dwordx4 v191, s[16:19], 0 offen lds
    s_cmp_ge_u32 s42, 2
    s_cbranch_scc1 k2_xs_2
    s_add_u32 m0, s50, 2048
    s_nop 0
    buffer_load_dwordx4 v192, s[16:19], 0 offen lds
k2_xs_2:
    buffer_load_dwordx2 v[194:195], v28, s[20:23], 0 offen
    buffer_load_dwordx2 v[180:181], v29, s[24:27], 0 offen offset:0
    buffer_load_dwordx2 v[182:183], v29, s[24:27], 0 offen offset:32
    buffer_load_dwordx2 v[184:185], v29, s[24:27], 0 offen offset:64
    buffer_load_dwordx2 v[186:187], v29, s[24:27], 0 offen offset:96
    buffer_load_dwordx2 v[188:189], v29, s[24:27], 0 offen offset:128
    s_mov_b32 s52, 2
k2_loop_y:
    s_add_u32 s44, s44, 18432
    s_cmp_eq_u32 s44, 129024
    s_cselect_b32 s44, 0, s44
    v_add_u32 v8, s44, v2
    v_add_u32 v9, s44, v3
    v_add_u32 v10, s44, v4
    s_waitcnt lgkmcnt(0)
    v_mfma_f32_16x16x32_bf16 v[32:35], v[112:115], v[132:135], v[32:35]
    s_barrier
    ds_read_b64_tr_b16 v[160:161], v8 offset:0
    ds_read_b64_tr_b16 v[162:163], v8 offset:512
    ds_read_b64_tr_b16 v[164:165], v9 offset:0
    v_mfma_f32_16x16x32_bf16 v[36:39], v[112:115], v[136:139], v[36:39]
    ds_read_b64_tr_b16 v[166:167], v9 offset:512
    ds_read_b128 v[140:143], v10 offset:0
    ds_read_b128 v[144:147], v10 offset:2048
    v_mfma_f32_16x16x32_bf16 v[40:43], v[116:119], v[132:135], v[40:43]
    ds_read_b128 v[148:151], v10 offset:4096
    ds_read_b128 v[152:155], v10 offset:6144
    ds_read_b128 v[156:159], v10 offset:8192
    v_mfma_f32_16x16x32_bf16 v[44:47], v[116:119], v[136:139], v[44:47]
    v_mfma_f32_16x16x32_bf16 v[48:51], v[120:123], v[132:135], v[48:51]
    v_mfma_f32_16x16x32_bf16 v[52:55], v[120:123], v[136:139], v[52:55]
    v_mfma_f32_16x16x32_bf16 v[56:59], v[124:127], v[132:135], v[56:59]
    v_mfma_f32_16x16x32_bf16 v[60:63], v[124:127], v[136:139], v[60:63]
    v_mfma_f32_16x16x32_bf16 v[64:67], v[128:131], v[132:135], v[64:67]
    v_mfma_f32_16x16x32_bf16 v[68:71], v[128:131], v[136:139], v[68:71]
    s_add_u32 s44, s44, 18432
    s_cmp_eq_u32 s44, 129024
    s_cselect_b32 s44, 0, s44
    v_add_u32 v8, s44, v2
    v_add_u32 v9, s44, v3
    v_add_u32 v10, s44, v4
    s_waitcnt lgkmcnt(0)
    v_mfma_f32_16x16x32_bf16 v[32:35], v[140:143], v[160:163], v[32:35]
    s_barrier
    ds_read_b64_tr_b16 v[132:133], v8 offset:0
    ds_read_b64_tr_b16 v[134:135], v8 offset:512
    ds_read_b64_tr_b16 v[136:137], v9 offset:0
    v_mfma_f32_16x16x32_bf16 v[36:39], v[140:143], v[164:167], v[36:39]
    ds_read_b64_tr_b16 v[138:139], v9 offset:512
    ds_read_b128 v[112:115], v10 offset:0
    ds_read_b128 v[116:119], v10 offset:2048
    v_mfma_f32_16x16x32_bf16 v[40:43], v[144:147], v[160:163], v[40:43]
    ds_read_b128 v[120:123], v10 offset:4096
    ds_read_b128 v[124:127], v10 offset:6144
    ds_read_b128 v[128:131], v10 offset:8192
    v_mfma_f32_16x16x32_bf16 v[44:47], v[144:147], v[164:167], v[44:47]
    v_mfma_f32_16x16x32_bf16 v[48:51], v[148:151], v[160:163], v[48:51]
    v_mfma_f32_16x16x32_bf16 v[52:55], v[148:151], v[164:167], v[52:55]
    v_mfma_f32_16x16x32_bf16 v[56:59], v[152:155], v[160:163], v[56:59]
    v_mfma_f32_16x16x32_bf16 v[60:63], v[152:155], v[164:167], v[60:63]
    v_mfma_f32_16x16x32_bf16 v[64:67], v[156:159], v[160:163], v[64:67]
    v_mfma_f32_16x16x32_bf16 v[68:71], v[156:159], v[164:167], v[68:71]
    s_add_u32 s52, s52, 1
    s_cmp_lt_u32 s52, 9
    s_cbranch_scc1 k2_loop_y
    s_add_u32 s44, s44, 18432
    s_cmp_eq_u32 s44, 129024
    s_cselect_b32 s44, 0, s44
    v_add_u32 v8, s44, v2
    v_add_u32 v9, s44, v3
    v_add_u32 v10, s44, v4
    s_waitcnt lgkmcnt(0)
    v_mfma_f32_16x16x32_bf16 v[32:35], v[112:115], v[132:135], v[32:35]
    s_barrier
    ds_read_b64_tr_b16 v[160:161], v8 offset:0
    ds_read_b64_tr_b16 v[162:163], v8 offset:512
    ds_read_b64_tr_b16 v[164:165], v9 offset:0
    v_mfma_f32_16x16x32_bf16 v[36:39], v[112:115], v[136:139], v[36:39]
    ds_read_b64_tr_b16 v[166:167], v9 offset:512
    ds_read_b128 v[140:143], v10 offset:0
    ds_read_b128 v[144:147], v10 offset:2048
    v_mfma_f32_16x16x32_bf16 v[40:43], v[116:119], v[132:135], v[40:43]
    ds_read_b128 v[148:151], v10 offset:4096
    ds_read_b128 v[152:155], v10 offset:6144
    ds_read_b128 v[156:159], v10 offset:8192
    v_mfma_f32_16x16x32_bf16 v[44:47], v[116:119], v[136:139], v[44:47]
    v_mfma_f32_16x16x32_bf16 v[48:51], v[120:123], v[132:135], v[48:51]
    v_mfma_f32_16x16x32_bf16 v[52:55], v[120:123], v[136:139], v[52:55]
    v_mfma_f32_16x16x32_bf16 v[56:59], v[124:127], v[132:135], v[56:59]
    v_mfma_f32_16x16x32_bf16 v[60:63], v[124:127], v[136:139], v[60:63]
    v_mfma_f32_16x16x32_bf16 v[64:67], v[128:131], v[132:135], v[64:67]
    v_mfma_f32_16x16x32_bf16 v[68:71], v[128:131], v[136:139], v[68:71]
    s_add_u32 s44, s44, 18432
    s_cmp_eq_u32 s44, 129024
    s_cselect_b32 s44, 0, s44
    v_add_u32 v8, s44, v2
    v_add_u32 v9, s44, v3
    v_add_u32 v10, s44, v5
    s_waitcnt lgkmcnt(0)
    v_mfma_f32_16x16x32_bf16 v[32:35], v[140:143], v[160:163], v[32:35]
    s_barrier
    ds_read_b64_tr_b16 v[132:133], v8 offset:0
    ds_read_b64_tr_b16 v[134:135], v8 offset:512
    ds_read_b64_tr_b16 v[136:137], v9 offset:0
    v_mfma_f32_16x16x32_bf16 v[36:39], v[140:143], v[164:167], v[36:39]
    ds_read_b64_tr_b16 v[138:139], v9 offset:512
    ds_read_b64_tr_b16 v[112:113], v10 offset:0
    ds_read_b64_tr_b16 v[114:115], v10 offset:1280
    v_mfma_f32_16x16x32_bf16 v[40:43], v[144:147], v[160:163], v[40:43]
    ds_read_b64_tr_b16 v[116:117], v10 offset:32
    ds_read_b64_tr_b16 v[118:119], v10 offset:1312
    ds_read_b64_tr_b16 v[120:121], v10 offset:64
    v_mfma_f32_16x16x32_bf16 v[44:47], v[144:147], v[164:167], v[44:47]
    ds_read_b64_tr_b16 v[122:123], v10 offset:1344
    ds_read_b64_tr_b16 v[124:125], v10 offset:96
    ds_read_b64_tr_b16 v[126:127], v10 offset:1376
    v_mfma_f32_16x16x32_bf16 v[48:51], v[148:151], v[160:163], v[48:51]
    ds_read_b64_tr_b16 v[128:129], v10 offset:128
    ds_read_b64_tr_b16 v[130:131], v10 offset:1408
    v_mfma_f32_16x16x32_bf16 v[52:55], v[148:151], v[164:167], v[52:55]
    v_mfma_f32_16x16x32_bf16 v[56:59], v[152:155], v[160:163], v[56:59]
    v_mfma_f32_16x16x32_bf16 v[60:63], v[152:155], v[164:167], v[60:63]
    v_mfma_f32_16x16x32_bf16 v[64:67], v[156:159], v[160:163], v[64:67]
    v_mfma_f32_16x16x32_bf16 v[68:71], v[156:159], v[164:167], v[68:71]
    s_add_u32 s44, s44, 18432
    s_cmp_eq_u32 s44, 129024
    s_cselect_b32 s44, 0, s44
    v_add_u32 v8, s44, v2
    v_add_u32 v9, s44, v3
    v_add_u32 v10, s44, v5
    s_waitcnt lgkmcnt(0)
    v_mfma_f32_16x16x32_bf16 v[72:75], v[112:115], v[132:135], v[72:75]
    s_barrier
    ds_read_b64_tr_b16 v[160:161], v8 offset:0
    ds_read_b64_tr_b16 v[162:163], v8 offset:512
    ds_read_b64_tr_b16 v[164:165], v9 offset:0
    v_mfma_f32_16x16x32_bf16 v[76:79], v[112:115], v[136:139], v[76:79]
    ds_read_b64_tr_b16 v[166:167], v9 offset:512
    ds_read_b64_tr_b16 v[140:141], v10 offset:0
    ds_read_b64_tr_b16 v[142:143], v10 offset:1280
    v_mfma_f32_16x16x32_bf16 v[80:83], v[116:119], v[132:135], v[80:83]
    ds_read_b64_tr_b16 v[144:145], v10 offset:32
    ds_read_b64_tr_b16 v[146:147], v10 offset:1312
    ds_read_b64_tr_b16 v[148:149], v10 offset:64
    v_mfma_f32_16x16x32_bf16 v[84:87], v[116:119], v[136:139], v[84:87]
    ds_read_b64_tr_b16 v[150:151], v10 offset:1344
    ds_read_b64_tr_b16 v[152:153], v10 offset:96
    ds_read_b64_tr_b16 v[154:155], v10 offset:1376
    v_mfma_f32_16x16x32_bf16 v[88:91], v[120:123], v[132:135], v[88:91]
    ds_read_b64_tr_b16 v[156:157], v10 offset:128
    ds_read_b64_tr_b16 v[158:159], v10 offset:1408
    v_mfma_f32_16x16x32_bf16 v[92:95], v[120:123], v[136:139], v[92:95]
    v_mfma_f32_16x16x32_bf16 v[96:99], v[124:127], v[132:135], v[96:99]
    v_mfma_f32_16x16x32_bf16 v[100:103], v[124:127], v[136:139], v[100:103]
    v_mfma_f32_16x16x32_bf16 v[104:107], v[128:131], v[132:135], v[104:107]
    v_mfma_f32_16x16x32_bf16 v[108:111], v[128:131], v[136:139], v[108:111]
    s_cmp_eq_u32 s55, 0
    s_cbranch_scc0 k2_yw_3
    ds_write_b128 v26, v[36:39] offset:0
    ds_write_b128 v26, v[44:47] offset:1024
    ds_write_b128 v26, v[52:55] offset:2048
    ds_write_b128 v26, v[60:63] offset:3072
    ds_write_b128 v26, v[68:71] offset:4096
    s_branch k2_yw_4
k2_yw_3:
    ds_write_b128 v26, v[32:35] offset:0
    ds_write_b128 v26, v[40:43] offset:1024
    ds_write_b128 v26, v[48:51] offset:2048
    ds_write_b128 v26, v[56:59] offset:3072
    ds_write_b128 v26, v[64:67] offset:4096
    s_nop 1
    v_mov_b32 v32, v36
    v_mov_b32 v33, v37
    v_mov_b32 v34, v38
    v_mov_b32 v35, v39
    v_mov_b32 v40, v44
    v_mov_b32 v41, v45
    v_mov_b32 v42, v46
    v_mov_b32 v43, v47
    v_mov_b32 v48, v52
    v_mov_b32 v49, v53
    v_mov_b32 v50, v54
    v_mov_b32 v51, v55
    v_mov_b32 v56, v60
    v_mov_b32 v57, v61
    v_mov_b32 v58, v62
    v_mov_b32 v59, v63
    v_mov_b32 v64, v68
    v_mov_b32 v65, v69
    v_mov_b32 v66, v70
    v_mov_b32 v67, v71
k2_yw_4:
    s_waitcnt vmcnt(0)
    s_add_u32 s44, s44, 18432
    s_cmp_eq_u32 s44, 129024
    s_cselect_b32 s44, 0, s44
    v_add_u32 v8, s44, v2
    v_add_u32 v9, s44, v3
    v_add_u32 v10, s44, v5
    s_waitcnt lgkmcnt(0)
    v_mfma_f32_16x16x32_bf16 v[72:75], v[140:143], v[160:163], v[72:75]
    s_barrier
    ds_read_b64_tr_b16 v[132:133], v8 offset:0
    ds_read_b64_tr_b16 v[134:135], v8 offset:512
    ds_read_b64_tr_b16 v[136:137], v9 offset:0
    v_mfma_f32_16x16x32_bf16 v[76:79], v[140:143], v[164:167], v[76:79]
    ds_read_b64_tr_b16 v[138:139], v9 offset:512
    ds_read_b64_tr_b16 v[112:113], v10 offset:0
    ds_read_b64_tr_b16 v[114:115], v10 offset:1280
    v_mfma_f32_16x16x32_bf16 v[80:83], v[144:147], v[160:163], v[80:83]
    ds_read_b64_tr_b16 v[116:117], v10 offset:32
    ds_read_b64_tr_b16 v[118:119], v10 offset:1312
    ds_read_b64_tr_b16 v[120:121], v10 offset:64
    v_mfma_f32_16x16x32_bf16 v[84:87], v[144:147], v[164:167], v[84:87]
    ds_read_b64_tr_b16 v[122:123], v10 offset:1344
    ds_read_b64_tr_b16 v[124:125], v10 offset:96
    ds_read_b64_tr_b16 v[126:127], v10 offset:1376
    v_mfma_f32_16x16x32_bf16 v[88:91], v[148:151], v[160:163], v[88:91]
    ds_read_b64_tr_b16 v[128:129], v10 offset:128
    ds_read_b64_tr_b16 v[130:131], v10 offset:1408
    v_mfma_f32_16x16x32_bf16 v[92:95], v[148:151], v[164:167], v[92:95]
    v_mfma_f32_16x16x32_bf16 v[96:99], v[152:155], v[160:163], v[96:99]
    v_mfma_f32_16x16x32_bf16 v[100:103], v[152:155], v[164:167], v[100:103]
    v_mfma_f32_16x16x32_bf16 v[104:107], v[156:159], v[160:163], v[104:107]
    v_mfma_f32_16x16x32_bf16 v[108:111], v[156:159], v[164:167], v[108:111]
    ds_read_b128 v[36:39], v27 offset:0
    ds_read_b128 v[44:47], v27 offset:1024
    ds_read_b128 v[52:55], v27 offset:2048
    ds_read_b128 v[60:63], v27 offset:3072
    ds_read_b128 v[68:71], v27 offset:4096
    ds_read_b64 v[168:169], v24 offset:0
    ds_read_b64 v[170:171], v24 offset:32
    ds_read_b64 v[172:173], v24 offset:64
    ds_read_b64 v[174:175], v24 offset:96
    ds_read_b64 v[176:177], v24 offset:128
    s_add_u32 s44, s44, 18432
    s_cmp_eq_u32 s44, 129024
    s_cselect_b32 s44, 0, s44
    v_add_u32 v8, s44, v2
    v_add_u32 v9, s44, v3
    v_add_u32 v10, s44, v5
    s_waitcnt lgkmcnt(0)
    v_mfma_f32_16x16x32_bf16 v[72:75], v[112:115], v[132:135], v[72:75]
    s_barrier
    ds_read_b64_tr_b16 v[160:161], v8 offset:0
    ds_read_b64_tr_b16 v[162:163], v8 offset:512
    ds_read_b64_tr_b16 v[164:165], v9 offset:0
    v_mfma_f32_16x16x32_bf16 v[76:79], v[112:115], v[136:139], v[76:79]
    ds_read_b64_tr_b16 v[166:167], v9 offset:512
    ds_read_b64_tr_b16 v[140:141], v10 offset:0
    ds_read_b64_tr_b16 v[142:143], v10 offset:1280
    v_mfma_f32_16x16x32_bf16 v[80:83], v[116:119], v[132:135], v[80:83]
    ds_read_b64_tr_b16 v[144:145], v10 offset:32
    ds_read_b64_tr_b16 v[146:147], v10 offset:1312
    ds_read_b64_tr_b16 v[148:149], v10 offset:64
    v_mfma_f32_16x16x32_bf16 v[84:87], v[116:119], v[136:139], v[84:87]
    ds_read_b64_tr_b16 v[150:151], v10 offset:1344
    ds_read_b64_tr_b16 v[152:153], v10 offset:96
    ds_read_b64_tr_b16 v[154:155], v10 offset:1376
    v_mfma_f32_16x16x32_bf16 v[88:91], v[120:123], v[132:135], v[88:91]
    ds_read_b64_tr_b16 v[156:157], v10 offset:128
    ds_read_b64_tr_b16 v[158:159], v10 offset:1408
    v_mfma_f32_16x16x32_bf16 v[92:95], v[120:123], v[136:139], v[92:95]
    v_mfma_f32_16x16x32_bf16 v[96:99], v[124:127], v[132:135], v[96:99]
    v_mfma_f32_16x16x32_bf16 v[100:103], v[124:127], v[136:139], v[100:103]
    v_mfma_f32_16x16x32_bf16 v[104:107], v[128:131], v[132:135], v[104:107]
    v_mfma_f32_16x16x32_bf16 v[108:111], v[128:131], v[136:139], v[108:111]
    v_add_f32 v32, v32, v36
    v_add_f32 v33, v33, v37
    v_add_f32 v34, v34, v38
    v_add_f32 v35, v35, v39
    v_lshlrev_b32 v36, 16, v168
    v_and_b32 v37, 0xffff0000, v168
    v_lshlrev_b32 v38, 16, v169
    v_and_b32 v39, 0xffff0000, v169
    v_sub_f32 v196, v36, v194
    v_sub_f32 v197, v37, v194
    v_sub_f32 v198, v38, v194
    v_sub_f32 v199, v39, v194
    v_cvt_pk_bf16_f32 v168, v196, v197
    v_cvt_pk_bf16_f32 v169, v198, v199
    v_lshlrev_b32 v196, 16, v168
    v_and_b32 v197, 0xffff0000, v168
    v_lshlrev_b32 v198, 16, v169
    v_and_b32 v199, 0xffff0000, v169
    v_mul_f32 v196, v196, v195
    v_mul_f32 v197, v197, v195
    v_mul_f32 v198, v198, v195
    v_mul_f32 v199, v199, v195
    v_cvt_pk_bf16_f32 v168, v196, v197
    v_cvt_pk_bf16_f32 v169, v198, v199
    v_lshlrev_b32 v196, 16, v168
    v_and_b32 v197, 0xffff0000, v168
    v_lshlrev_b32 v198, 16, v169
    v_and_b32 v199, 0xffff0000, v169
    v_lshlrev_b32 v200, 16, v180
    v_and_b32 v201, 0xffff0000, v180
    v_lshlrev_b32 v202, 16, v181
    v_and_b32 v203, 0xffff0000, v181
    v_mul_f32 v196, v196, v200
    v_mul_f32 v197, v197, v201
    v_mul_f32 v198, v198, v202
    v_mul_f32 v199, v199, v203
    v_cvt_pk_bf16_f32 v168, v196, v197
    v_cvt_pk_bf16_f32 v169, v198, v199
    v_lshlrev_b32 v196, 16, v168
    v_and_b32 v197, 0xffff0000, v168
    v_lshlrev_b32 v198, 16, v169
    v_and_b32 v199, 0xffff0000, v169
    v_add_f32 v32, v32, v196
    v_add_f32 v33, v33, v197
    v_add_f32 v34, v34, v198
    v_add_f32 v35, v35, v199
    s_add_u32 s44, s44, 18432
    s_cmp_eq_u32 s44, 129024
    s_cselect_b32 s44, 0, s44
    v_add_u32 v8, s44, v2
    v_add_u32 v9, s44, v3
    v_add_u32 v10, s44, v5
    s_waitcnt lgkmcnt(0)
    v_mfma_f32_16x16x32_bf16 v[72:75], v[140:143], v[160:163], v[72:75]
    s_barrier
    ds_read_b64_tr_b16 v[132:133], v8 offset:0
    ds_read_b64_tr_b16 v[134:135], v8 offset:512
    ds_read_b64_tr_b16 v[136:137], v9 offset:0
    v_mfma_f32_16x16x32_bf16 v[76:79], v[140:143], v[164:167], v[76:79]
    ds_read_b64_tr_b16 v[138:139], v9 offset:512
    ds_read_b64_tr_b16 v[112:113], v10 offset:0
    ds_read_b64_tr_b16 v[114:115], v10 offset:1280
    v_mfma_f32_16x16x32_bf16 v[80:83], v[144:147], v[160:163], v[80:83]
    ds_read_b64_tr_b16 v[116:117], v10 offset:32
    ds_read_b64_tr_b16 v[118:119], v10 offset:1312
    ds_read_b64_tr_b16 v[120:121], v10 offset:64
    v_mfma_f32_16x16x32_bf16 v[84:87], v[144:147], v[164:167], v[84:87]
    ds_read_b64_tr_b16 v[122:123], v10 offset:1344
    ds_read_b64_tr_b16 v[124:125], v10 offset:96
    ds_read_b64_tr_b16 v[126:127], v10 offset:1376
    v_mfma_f32_16x16x32_bf16 v[88:91], v[148:151], v[160:163], v[88:91]
    ds_read_b64_tr_b16 v[128:129], v10 offset:128
    ds_read_b64_tr_b16 v[130:131], v10 offset:1408
    v_mfma_f32_16x16x32_bf16 v[92:95], v[148:151], v[164:167], v[92:95]
    v_mfma_f32_16x16x32_bf16 v[96:99], v[152:155], v[160:163], v[96:99]
    v_mfma_f32_16x16x32_bf16 v[100:103], v[152:155], v[164:167], v[100:103]
    v_mfma_f32_16x16x32_bf16 v[104:107], v[156:159], v[160:163], v[104:107]
    v_mfma_f32_16x16x32_bf16 v[108:111], v[156:159], v[164:167], v[108:111]
    v_add_f32 v40, v40, v44
    v_add_f32 v41, v41, v45
    v_add_f32 v42, v42, v46
    v_add_f32 v43, v43, v47
    v_lshlrev_b32 v44, 16, v170
    v_and_b32 v45, 0xffff0000, v170
    v_lshlrev_b32 v46, 16, v171
    v_and_b32 v47, 0xffff0000, v171
    v_sub_f32 v196, v44, v194
    v_sub_f32 v197, v45, v194
    v_sub_f32 v198, v46, v194
    v_sub_f32 v199, v47, v194
    v_cvt_pk_bf16_f32 v170, v196, v197
    v_cvt_pk_bf16_f32 v171, v198, v199
    v_lshlrev_b32 v196, 16, v170
    v_and_b32 v197, 0xffff0000, v170
    v_lshlrev_b32 v198, 16, v171
    v_and_b32 v199, 0xffff0000, v171
    v_mul_f32 v196, v196, v195
    v_mul_f32 v197, v197, v195
    v_mul_f32 v198, v198, v195
    v_mul_f32 v199, v199, v195
    v_cvt_pk_bf16_f32 v170, v196, v197
    v_cvt_pk_bf16_f32 v171, v198, v199
    v_lshlrev_b32 v196, 16, v170
    v_and_b32 v197, 0xffff0000, v170
    v_lshlrev_b32 v198, 16, v171
    v_and_b32 v199, 0xffff0000, v171
    v_lshlrev_b32 v200, 16, v182
    v_and_b32 v201, 0xffff0000, v182
    v_lshlrev_b32 v202, 16, v183
    v_and_b32 v203, 0xffff0000, v183
    v_mul_f32 v196, v196, v200
    v_mul_f32 v197, v197, v201
    v_mul_f32 v198, v198, v202
    v_mul_f32 v199, v199, v203
    v_cvt_pk_bf16_f32 v170, v196, v197
    v_cvt_pk_bf16_f32 v171, v198, v199
    v_lshlrev_b32 v196, 16, v170
    v_and_b32 v197, 0xffff0000, v170
    v_lshlrev_b32 v198, 16, v171
    v_and_b32 v199, 0xffff0000, v171
    v_add_f32 v40, v40, v196
    v_add_f32 v41, v41, v197
    v_add_f32 v42, v42, v198
    v_add_f32 v43, v43, v199
    s_add_u32 s44, s44, 18432
    s_cmp_eq_u32 s44, 129024
    s_cselect_b32 s44, 0, s44
    v_add_u32 v8, s44, v2
    v_add_u32 v9, s44, v3
    v_add_u32 v10, s44, v5
    s_waitcnt lgkmcnt(0)
    v_mfma_f32_16x16x32_bf16 v[72:75], v[112:115], v[132:135], v[72:75]
    s_barrier
    ds_read_b64_tr_b16 v[160:161], v8 offset:0
    ds_read_b64_tr_b16 v[162:163], v8 offset:512
    ds_read_b64_tr_b16 v[164:165], v9 offset:0
    v_mfma_f32_16x16x32_bf16 v[76:79], v[112:115], v[136:139], v[76:79]
    ds_read_b64_tr_b16 v[166:167], v9 offset:512
    ds_read_b64_tr_b16 v[140:141], v10 offset:0
    ds_read_b64_tr_b16 v[142:143], v10 offset:1280
    v_mfma_f32_16x16x32_bf16 v[80:83], v[116:119], v[132:135], v[80:83]
    ds_read_b64_tr_b16 v[144:145], v10 offset:32
    ds_read_b64_tr_b16 v[146:147], v10 offset:1312
    ds_read_b64_tr_b16 v[148:149], v10 offset:64
    v_mfma_f32_16x16x32_bf16 v[84:87], v[116:119], v[136:139], v[84:87]
    ds_read_b64_tr_b16 v[150:151], v10 offset:1344
    ds_read_b64_tr_b16 v[152:153], v10 offset:96
    ds_read_b64_tr_b16 v[154:155], v10 offset:1376
    v_mfma_f32_16x16x32_bf16 v[88:91], v[120:123], v[132:135], v[88:91]
    ds_read_b64_tr_b16 v[156:157], v10 offset:128
    ds_read_b64_tr_b16 v[158:159], v10 offset:1408
    v_mfma_f32_16x16x32_bf16 v[92:95], v[120:123], v[136:139], v[92:95]
    v_mfma_f32_16x16x32_bf16 v[96:99], v[124:127], v[132:135], v[96:99]
    v_mfma_f32_16x16x32_bf16 v[100:103], v[124:127], v[136:139], v[100:103]
    v_mfma_f32_16x16x32_bf16 v[104:107], v[128:131], v[132:135], v[104:107]
    v_mfma_f32_16x16x32_bf16 v[108:111], v[128:131], v[136:139], v[108:111]
    v_add_f32 v48, v48, v52
    v_add_f32 v49, v49, v53
    v_add_f32 v50, v50, v54
    v_add_f32 v51, v51, v55
    v_lshlrev_b32 v52, 16, v172
    v_and_b32 v53, 0xffff0000, v172
    v_lshlrev_b32 v54, 16, v173
    v_and_b32 v55, 0xffff0000, v173
    v_sub_f32 v196, v52, v194
    v_sub_f32 v197, v53, v194
    v_sub_f32 v198, v54, v194
    v_sub_f32 v199, v55, v194
    v_cvt_pk_bf16_f32 v172, v196, v197
    v_cvt_pk_bf16_f32 v173, v198, v199
    v_lshlrev_b32 v196, 16, v172
    v_and_b32 v197, 0xffff0000, v172
    v_lshlrev_b32 v198, 16, v173
    v_and_b32 v199, 0xffff0000, v173
    v_mul_f32 v196, v196, v195
    v_mul_f32 v197, v197, v195
    v_mul_f32 v198, v198, v195
    v_mul_f32 v199, v199, v195
    v_cvt_pk_bf16_f32 v172, v196, v197
    v_cvt_pk_bf16_f32 v173, v198, v199
    v_lshlrev_b32 v196, 16, v172
    v_and_b32 v197, 0xffff0000, v172
    v_lshlrev_b32 v198, 16, v173
    v_and_b32 v199, 0xffff0000, v173
    v_lshlrev_b32 v200, 16, v184
    v_and_b32 v201, 0xffff0000, v184
    v_lshlrev_b32 v202, 16, v185
    v_and_b32 v203, 0xffff0000, v185
    v_mul_f32 v196, v196, v200
    v_mul_f32 v197, v197, v201
    v_mul_f32 v198, v198, v202
    v_mul_f32 v199, v199, v203
    v_cvt_pk_bf16_f32 v172, v196, v197
    v_cvt_pk_bf16_f32 v173, v198, v199
    v_lshlrev_b32 v196, 16, v172
    v_and_b32 v197, 0xffff0000, v172
    v_lshlrev_b32 v198, 16, v173
    v_and_b32 v199, 0xffff0000, v173
    v_add_f32 v48, v48, v196
    v_add_f32 v49, v49, v197
    v_add_f32 v50, v50, v198
    v_add_f32 v51, v51, v199
    s_add_u32 s44, s44, 18432
    s_cmp_eq_u32 s44, 129024
    s_cselect_b32 s44, 0, s44
    v_add_u32 v8, s44, v2
    v_add_u32 v9, s44, v3
    v_add_u32 v10, s44, v5
    s_waitcnt lgkmcnt(0)
    v_mfma_f32_16x16x32_bf16 v[72:75], v[140:143], v[160:163], v[72:75]
    s_barrier
    ds_read_b64_tr_b16 v[132:133], v8 offset:0
    ds_read_b64_tr_b16 v[134:135], v8 offset:512
    ds_read_b64_tr_b16 v[136:137], v9 offset:0
    v_mfma_f32_16x16x32_bf16 v[76:79], v[140:143], v[164:167], v[76:79]
    ds_read_b64_tr_b16 v[138:139], v9 offset:512
    ds_read_b64_tr_b16 v[112:113], v10 offset:0
    ds_read_b64_tr_b16 v[114:115], v10 offset:1280
    v_mfma_f32_16x16x32_bf16 v[80:83], v[144:147], v[160:163], v[80:83]
    ds_read_b64_tr_b16 v[116:117], v10 offset:32
    ds_read_b64_tr_b16 v[118:119], v10 offset:1312
    ds_read_b64_tr_b16 v[120:121], v10 offset:64
    v_mfma_f32_16x16x32_bf16 v[84:87], v[144:147], v[164:167], v[84:87]
    ds_read_b64_tr_b16 v[122:123], v10 offset:1344
    ds_read_b64_tr_b16 v[124:125], v10 offset:96
    ds_read_b64_tr_b16 v[126:127], v10 offset:1376
    v_mfma_f32_16x16x32_bf16 v[88:91], v[148:151], v[160:163], v[88:91]
    ds_read_b64_tr_b16 v[128:129], v10 offset:128
    ds_read_b64_tr_b16 v[130:131], v10 offset:1408
    v_mfma_f32_16x16x32_bf16 v[92:95], v[148:151], v[164:167], v[92:95]
    v_mfma_f32_16x16x32_bf16 v[96:99], v[152:155], v[160:163], v[96:99]
    v_mfma_f32_16x16x32_bf16 v[100:103], v[152:155], v[164:167], v[100:103]
    v_mfma_f32_16x16x32_bf16 v[104:107], v[156:159], v[160:163], v[104:107]
    v_mfma_f32_16x16x32_bf16 v[108:111], v[156:159], v[164:167], v[108:111]
    v_add_f32 v56, v56, v60
    v_add_f32 v57, v57, v61
    v_add_f32 v58, v58, v62
    v_add_f32 v59, v59, v63
    v_lshlrev_b32 v60, 16, v174
    v_and_b32 v61, 0xffff0000, v174
    v_lshlrev_b32 v62, 16, v175
    v_and_b32 v63, 0xffff0000, v175
    v_sub_f32 v196, v60, v194
    v_sub_f32 v197, v61, v194
    v_sub_f32 v198, v62, v194
    v_sub_f32 v199, v63, v194
    v_cvt_pk_bf16_f32 v174, v196, v197
    v_cvt_pk_bf16_f32 v175, v198, v199
    v_lshlrev_b32 v196, 16, v174
    v_and_b32 v197, 0xffff0000, v174
    v_lshlrev_b32 v198, 16, v175
    v_and_b32 v199, 0xffff0000, v175
    v_mul_f32 v196, v196, v195
    v_mul_f32 v197, v197, v195
    v_mul_f32 v198, v198, v195
    v_mul_f32 v199, v199, v195
    v_cvt_pk_bf16_f32 v174, v196, v197
    v_cvt_pk_bf16_f32 v175, v198, v199
    v_lshlrev_b32 v196, 16, v174
    v_and_b32 v197, 0xffff0000, v174
    v_lshlrev_b32 v198, 16, v175
    v_and_b32 v199, 0xffff0000, v175
    v_lshlrev_b32 v200, 16, v186
    v_and_b32 v201, 0xffff0000, v186
    v_lshlrev_b32 v202, 16, v187
    v_and_b32 v203, 0xffff0000, v187
    v_mul_f32 v196, v196, v200
    v_mul_f32 v197, v197, v201
    v_mul_f32 v198, v198, v202
    v_mul_f32 v199, v199, v203
    v_cvt_pk_bf16_f32 v174, v196, v197
    v_cvt_pk_bf16_f32 v175, v198, v199
    v_lshlrev_b32 v196, 16, v174
    v_and_b32 v197, 0xffff0000, v174
    v_lshlrev_b32 v198, 16, v175
    v_and_b32 v199, 0xffff0000, v175
    v_add_f32 v56, v56, v196
    v_add_f32 v57, v57, v197
    v_add_f32 v58, v58, v198
    v_add_f32 v59, v59, v199
    s_add_u32 s44, s44, 18432
    s_cmp_eq_u32 s44, 129024
    s_cselect_b32 s44, 0, s44
    v_add_u32 v8, s44, v2
    v_add_u32 v9, s44, v3
    v_add_u32 v10, s44, v5
    s_waitcnt lgkmcnt(0)
    v_mfma_f32_16x16x32_bf16 v[72:75], v[112:115], v[132:135], v[72:75]
    s_barrier
    ds_read_b64_tr_b16 v[160:161], v8 offset:0
    ds_read_b64_tr_b16 v[162:163], v8 offset:512
    ds_read_b64_tr_b16 v[164:165], v9 offset:0
    v_mfma_f32_16x16x32_bf16 v[76:79], v[112:115], v[136:139], v[76:79]
    ds_read_b64_tr_b16 v[166:167], v9 offset:512
    ds_read_b64_tr_b16 v[140:141], v10 offset:0
    ds_read_b64_tr_b16 v[142:143], v10 offset:1280
    v_mfma_f32_16x16x32_bf16 v[80:83], v[116:119], v[132:135], v[80:83]
    ds_read_b64_tr_b16 v[144:145], v10 offset:32
    ds_read_b64_tr_b16 v[146:147], v10 offset:1312
    ds_read_b64_tr_b16 v[148:149], v10 offset:64
    v_mfma_f32_16x16x32_bf16 v[84:87], v[116:119], v[136:139], v[84:87]
    ds_read_b64_tr_b16 v[150:151], v10 offset:1344
    ds_read_b64_tr_b16 v[152:153], v10 offset:96
    ds_read_b64_tr_b16 v[154:155], v10 offset:1376
    v_mfma_f32_16x16x32_bf16 v[88:91], v[120:123], v[132:135], v[88:91]
    ds_read_b64_tr_b16 v[156:157], v10 offset:128
    ds_read_b64_tr_b16 v[158:159], v10 offset:1408
    v_mfma_f32_16x16x32_bf16 v[92:95], v[120:123], v[136:139], v[92:95]
    v_mfma_f32_16x16x32_bf16 v[96:99], v[124:127], v[132:135], v[96:99]
    v_mfma_f32_16x16x32_bf16 v[100:103], v[124:127], v[136:139], v[100:103]
    v_mfma_f32_16x16x32_bf16 v[104:107], v[128:131], v[132:135], v[104:107]
    v_mfma_f32_16x16x32_bf16 v[108:111], v[128:131], v[136:139], v[108:111]
    v_add_f32 v64, v64, v68
    v_add_f32 v65, v65, v69
    v_add_f32 v66, v66, v70
    v_add_f32 v67, v67, v71
    v_lshlrev_b32 v68, 16, v176
    v_and_b32 v69, 0xffff0000, v176
    v_lshlrev_b32 v70, 16, v177
    v_and_b32 v71, 0xffff0000, v177
    v_sub_f32 v196, v68, v194
    v_sub_f32 v197, v69, v194
    v_sub_f32 v198, v70, v194
    v_sub_f32 v199, v71, v194
    v_cvt_pk_bf16_f32 v176, v196, v197
    v_cvt_pk_bf16_f32 v177, v198, v199
    v_lshlrev_b32 v196, 16, v176
    v_and_b32 v197, 0xffff0000, v176
    v_lshlrev_b32 v198, 16, v177
    v_and_b32 v199, 0xffff0000, v177
    v_mul_f32 v196, v196, v195
    v_mul_f32 v197, v197, v195
    v_mul_f32 v198, v198, v195
    v_mul_f32 v199, v199, v195
    v_cvt_pk_bf16_f32 v176, v196, v197
    v_cvt_pk_bf16_f32 v177, v198, v199
    v_lshlrev_b32 v196, 16, v176
    v_and_b32 v197, 0xffff0000, v176
    v_lshlrev_b32 v198, 16, v177
    v_and_b32 v199, 0xffff0000, v177
    v_lshlrev_b32 v200, 16, v188
    v_and_b32 v201, 0xffff0000, v188
    v_lshlrev_b32 v202, 16, v189
    v_and_b32 v203, 0xffff0000, v189
    v_mul_f32 v196, v196, v200
    v_mul_f32 v197, v197, v201
    v_mul_f32 v198, v198, v202
    v_mul_f32 v199, v199, v203
    v_cvt_pk_bf16_f32 v176, v196, v197
    v_cvt_pk_bf16_f32 v177, v198, v199
    v_lshlrev_b32 v196, 16, v176
    v_and_b32 v197, 0xffff0000, v176
    v_lshlrev_b32 v198, 16, v177
    v_and_b32 v199, 0xffff0000, v177
    v_add_f32 v64, v64, v196
    v_add_f32 v65, v65, v197
    v_add_f32 v66, v66, v198
    v_add_f32 v67, v67, v199
    s_add_u32 s44, s44, 18432
    s_cmp_eq_u32 s44, 129024
    s_cselect_b32 s44, 0, s44
    v_add_u32 v8, s44, v2
    v_add_u32 v9, s44, v3
    v_add_u32 v10, s44, v5
    s_waitcnt lgkmcnt(0)
    v_mfma_f32_16x16x32_bf16 v[72:75], v[140:143], v[160:163], v[72:75]
    s_barrier
    ds_read_b64_tr_b16 v[132:133], v8 offset:0
    ds_read_b64_tr_b16 v[134:135], v8 offset:512
    ds_read_b64_tr_b16 v[136:137], v9 offset:0
    v_mfma_f32_16x16x32_bf16 v[76:79], v[140:143], v[164:167], v[76:79]
    ds_read_b64_tr_b16 v[138:139], v9 offset:512
    ds_read_b64_tr_b16 v[112:113], v10 offset:0
    ds_read_b64_tr_b16 v[114:115], v10 offset:1280
    v_mfma_f32_16x16x32_bf16 v[80:83], v[144:147], v[160:163], v[80:83]
    ds_read_b64_tr_b16 v[116:117], v10 offset:32
    ds_read_b64_tr_b16 v[118:119], v10 offset:1312
    ds_read_b64_tr_b16 v[120:121], v10 offset:64
    v_mfma_f32_16x16x32_bf16 v[84:87], v[144:147], v[164:167], v[84:87]
    ds_read_b64_tr_b16 v[122:123], v10 offset:1344
    ds_read_b64_tr_b16 v[124:125], v10 offset:96
    ds_read_b64_tr_b16 v[126:127], v10 offset:1376
    v_mfma_f32_16x16x32_bf16 v[88:91], v[148:151], v[160:163], v[88:91]
    ds_read_b64_tr_b16 v[128:129], v10 offset:128
    ds_read_b64_tr_b16 v[130:131], v10 offset:1408
    v_mfma_f32_16x16x32_bf16 v[92:95], v[148:151], v[164:167], v[92:95]
    v_mfma_f32_16x16x32_bf16 v[96:99], v[152:155], v[160:163], v[96:99]
    v_mfma_f32_16x16x32_bf16 v[100:103], v[152:155], v[164:167], v[100:103]
    v_mfma_f32_16x16x32_bf16 v[104:107], v[156:159], v[160:163], v[104:107]
    v_mfma_f32_16x16x32_bf16 v[108:111], v[156:159], v[164:167], v[108:111]
    s_mov_b32 s52, 4
k2_loop_f:
    s_add_u32 s44, s44, 18432
    s_cmp_eq_u32 s44, 129024
    s_cselect_b32 s44, 0, s44
    v_add_u32 v8, s44, v2
    v_add_u32 v9, s44, v3
    v_add_u32 v10, s44, v5
    s_waitcnt lgkmcnt(0)
    v_mfma_f32_16x16x32_bf16 v[72:75], v[112:115], v[132:135], v[72:75]
    s_barrier
    ds_read_b64_tr_b16 v[160:161], v8 offset:0
    ds_read_b64_tr_b16 v[162:163], v8 offset:512
    ds_read_b64_tr_b16 v[164:165], v9 offset:0
    v_mfma_f32_16x16x32_bf16 v[76:79], v[112:115], v[136:139], v[76:79]
    ds_read_b64_tr_b16 v[166:167], v9 offset:512
    ds_read_b64_tr_b16 v[140:141], v10 offset:0
    ds_read_b64_tr_b16 v[142:143], v10 offset:1280
    v_mfma_f32_16x16x32_bf16 v[80:83], v[116:119], v[132:135], v[80:83]
    ds_read_b64_tr_b16 v[144:145], v10 offset:32
    ds_read_b64_tr_b16 v[146:147], v10 offset:1312
    ds_read_b64_tr_b16 v[148:149], v10 offset:64
    v_mfma_f32_16x16x32_bf16 v[84:87], v[116:119], v[136:139], v[84:87]
    ds_read_b64_tr_b16 v[150:151], v10 offset:1344
    ds_read_b64_tr_b16 v[152:153], v10 offset:96
    ds_read_b64_tr_b16 v[154:155], v10 offset:1376
    v_mfma_f32_16x16x32_bf16 v[88:91], v[120:123], v[132:135], v[88:91]
    ds_read_b64_tr_b16 v[156:157], v10 offset:128
    ds_read_b64_tr_b16 v[158:159], v10 offset:1408
    v_mfma_f32_16x16x32_bf16 v[92:95], v[120:123], v[136:139], v[92:95]
    v_mfma_f32_16x16x32_bf16 v[96:99], v[124:127], v[132:135], v[96:99]
    v_mfma_f32_16x16x32_bf16 v[100:103], v[124:127], v[136:139], v[100:103]
    v_mfma_f32_16x16x32_bf16 v[104:107], v[128:131], v[132:135], v[104:107]
    v_mfma_f32_16x16x32_bf16 v[108:111], v[128:131], v[136:139], v[108:111]
    s_add_u32 s44, s44, 18432
    s_cmp_eq_u32 s44, 129024
    s_cselect_b32 s44, 0, s44
    v_add_u32 v8, s44, v2
    v_add_u32 v9, s44, v3
    v_add_u32 v10, s44, v5
    s_waitcnt lgkmcnt(0)
    v_mfma_f32_16x16x32_bf16 v[72:75], v[140:143], v[160:163], v[72:75]
    s_barrier
    ds_read_b64_tr_b16 v[132:133], v8 offset:0
    ds_read_b64_tr_b16 v[134:135], v8 offset:512
    ds_read_b64_tr_b16 v[136:137], v9 offset:0
    v_mfma_f32_16x16x32_bf16 v[76:79], v[140:143], v[164:167], v[76:79]
    ds_read_b64_tr_b16 v[138:139], v9 offset:512
    ds_read_b64_tr_b16 v[112:113], v10 offset:0
    ds_read_b64_tr_b16 v[114:115], v10 offset:1280
    v_mfma_f32_16x16x32_bf16 v[80:83], v[144:147], v[160:163], v[80:83]
    ds_read_b64_tr_b16 v[116:117], v10 offset:32
    ds_read_b64_tr_b16 v[118:119], v10 offset:1312
    ds_read_b64_tr_b16 v[120:121], v10 offset:64
    v_mfma_f32_16x16x32_bf16 v[84:87], v[144:147], v[164:167], v[84:87]
    ds_read_b64_tr_b16 v[122:123], v10 offset:1344
    ds_read_b64_tr_b16 v[124:125], v10 offset:96
    ds_read_b64_tr_b16 v[126:127], v10 offset:1376
    v_mfma_f32_16x16x32_bf16 v[88:91], v[148:151], v[160:163], v[88:91]
    ds_read_b64_tr_b16 v[128:129], v10 offset:128
    ds_read_b64_tr_b16 v[130:131], v10 offset:1408
    v_mfma_f32_16x16x32_bf16 v[92:95], v[148:151], v[164:167], v[92:95]
    v_mfma_f32_16x16x32_bf16 v[96:99], v[152:155], v[160:163], v[96:99]
    v_mfma_f32_16x16x32_bf16 v[100:103], v[152:155], v[164:167], v[100:103]
    v_mfma_f32_16x16x32_bf16 v[104:107], v[156:159], v[160:163], v[104:107]
    v_mfma_f32_16x16x32_bf16 v[108:111], v[156:159], v[164:167], v[108:111]
    s_add_u32 s52, s52, 1
    s_cmp_lt_u32 s52, 13
    s_cbranch_scc1 k2_loop_f
    s_add_u32 s44, s44, 18432
    s_cmp_eq_u32 s44, 129024
    s_cselect_b32 s44, 0, s44
    s_waitcnt lgkmcnt(0)
    v_mfma_f32_16x16x32_bf16 v[72:75], v[112:115], v[132:135], v[72:75]
    s_barrier
    v_mfma_f32_16x16x32_bf16 v[76:79], v[112:115], v[136:139], v[76:79]
    v_mfma_f32_16x16x32_bf16 v[80:83], v[116:119], v[132:135], v[80:83]
    v_mfma_f32_16x16x32_bf16 v[84:87], v[116:119], v[136:139], v[84:87]
    v_mfma_f32_16x16x32_bf16 v[88:91], v[120:123], v[132:135], v[88:91]
    v_mfma_f32_16x16x32_bf16 v[92:95], v[120:123], v[136:139], v[92:95]
    v_mfma_f32_16x16x32_bf16 v[96:99], v[124:127], v[132:135], v[96:99]
    v_mfma_f32_16x16x32_bf16 v[100:103], v[124:127], v[136:139], v[100:103]
    v_mfma_f32_16x16x32_bf16 v[104:107], v[128:131], v[132:135], v[104:107]
    v_mfma_f32_16x16x32_bf16 v[108:111], v[128:131], v[136:139], v[108:111]
    s_nop 7
    s_nop 3
    s_cmp_eq_u32 s55, 0
    s_cbranch_scc0 k2_epi1
    ds_write_b128 v20, v[76:79] offset:0
    ds_write_b128 v20, v[84:87] offset:1024
    ds_write_b128 v20, v[92:95] offset:2048
    ds_write_b128 v20, v[100:103] offset:3072
    ds_write_b128 v20, v[108:111] offset:4096
    s_waitcnt lgkmcnt(0)
    s_barrier
    ds_read_b128 v[76:79], v21 offset:0
    ds_read_b128 v[84:87], v21 offset:1024
    ds_read_b128 v[92:95], v21 offset:2048
    ds_read_b128 v[100:103], v21 offset:3072
    ds_read_b128 v[108:111], v21 offset:4096
    s_waitcnt lgkmcnt(4)
    v_add_f32 v72, v72, v76
    v_add_f32 v73, v73, v77
    v_add_f32 v74, v74, v78
    v_add_f32 v75, v75, v79
    v_cvt_pk_bf16_f32 v136, v72, v73
    v_cvt_pk_bf16_f32 v137, v74, v75
    v_lshlrev_b32 v72, 16, v136
    v_and_b32 v73, 0xffff0000, v136
    v_lshlrev_b32 v74, 16, v137
    v_and_b32 v75, 0xffff0000, v137
    v_mul_f32 v138, 0xbfb8aa3b, v72
    v_mul_f32 v139, 0xbfb8aa3b, v73
    v_mul_f32 v140, 0xbfb8aa3b, v74
    v_mul_f32 v141, 0xbfb8aa3b, v75
    v_exp_f32 v138, v138
    v_exp_f32 v139, v139
    v_exp_f32 v140, v140
    v_exp_f32 v141, v141
    s_nop 0
    v_add_f32 v138, 1.0, v138
    v_add_f32 v139, 1.0, v139
    v_add_f32 v140, 1.0, v140
    v_add_f32 v141, 1.0, v141
    v_rcp_f32 v138, v138
    v_rcp_f32 v139, v139
    v_rcp_f32 v140, v140
    v_rcp_f32 v141, v141
    s_nop 0
    v_mul_f32 v72, v72, v138
    v_mul_f32 v73, v73, v139
    v_mul_f32 v74, v74, v140
    v_mul_f32 v75, v75, v141
    v_cvt_pk_bf16_f32 v136, v72, v73
    v_cvt_pk_bf16_f32 v137, v74, v75
    v_lshlrev_b32 v72, 16, v136
    v_and_b32 v73, 0xffff0000, v136
    v_lshlrev_b32 v74, 16, v137
    v_and_b32 v75, 0xffff0000, v137
    v_mul_f32 v32, v32, v72
    v_mul_f32 v33, v33, v73
    v_mul_f32 v34, v34, v74
    v_mul_f32 v35, v35, v75
    v_add_f32 v32, v32, v36
    v_add_f32 v33, v33, v37
    v_add_f32 v34, v34, v38
    v_add_f32 v35, v35, v39
    buffer_store_dwordx4 v[32:35], v25, s[12:15], 0 offen offset:0 nt
    s_waitcnt lgkmcnt(3)
    v_add_f32 v80, v80, v84
    v_add_f32 v81, v81, v85
    v_add_f32 v82, v82, v86
    v_add_f32 v83, v83, v87
    v_cvt_pk_bf16_f32 v142, v80, v81
    v_cvt_pk_bf16_f32 v143, v82, v83
    v_lshlrev_b32 v80, 16, v142
    v_and_b32 v81, 0xffff0000, v142
    v_lshlrev_b32 v82, 16, v143
    v_and_b32 v83, 0xffff0000, v143
    v_mul_f32 v144, 0xbfb8aa3b, v80
    v_mul_f32 v145, 0xbfb8aa3b, v81
    v_mul_f32 v146, 0xbfb8aa3b, v82
    v_mul_f32 v147, 0xbfb8aa3b, v83
    v_exp_f32 v144, v144
    v_exp_f32 v145, v145
    v_exp_f32 v146, v146
    v_exp_f32 v147, v147
    s_nop 0
    v_add_f32 v144, 1.0, v144
    v_add_f32 v145, 1.0, v145
    v_add_f32 v146, 1.0, v146
    v_add_f32 v147, 1.0, v147
    v_rcp_f32 v144, v144
    v_rcp_f32 v145, v145
    v_rcp_f32 v146, v146
    v_rcp_f32 v147, v147
    s_nop 0
    v_mul_f32 v80, v80, v144
    v_mul_f32 v81, v81, v145
    v_mul_f32 v82, v82, v146
    v_mul_f32 v83, v83, v147
    v_cvt_pk_bf16_f32 v142, v80, v81
    v_cvt_pk_bf16_f32 v143, v82, v83
    v_lshlrev_b32 v80, 16, v142
    v_and_b32 v81, 0xffff0000, v142
    v_lshlrev_b32 v82, 16, v143
    v_and_b32 v83, 0xffff0000, v143
    v_mul_f32 v40, v40, v80
    v_mul_f32 v41, v41, v81
    v_mul_f32 v42, v42, v82
    v_mul_f32 v43, v43, v83
    v_add_f32 v40, v40, v44
    v_add_f32 v41, v41, v45
    v_add_f32 v42, v42, v46
    v_add_f32 v43, v43, v47
    buffer_store_dwordx4 v[40:43], v25, s[12:15], 0 offen offset:64 nt
    s_waitcnt lgkmcnt(2)
    v_add_f32 v88, v88, v92
    v_add_f32 v89, v89, v93
    v_add_f32 v90, v90, v94
    v_add_f32 v91, v91, v95
    v_cvt_pk_bf16_f32 v148, v88, v89
    v_cvt_pk_bf16_f32 v149, v90, v91
    v_lshlrev_b32 v88, 16, v148
    v_and_b32 v89, 0xffff0000, v148
    v_lshlrev_b32 v90, 16, v149
    v_and_b32 v91, 0xffff0000, v149
    v_mul_f32 v150, 0xbfb8aa3b, v88
    v_mul_f32 v151, 0xbfb8aa3b, v89
    v_mul_f32 v152, 0xbfb8aa3b, v90
    v_mul_f32 v153, 0xbfb8aa3b, v91
    v_exp_f32 v150, v150
    v_exp_f32 v151, v151
    v_exp_f32 v152, v152
    v_exp_f32 v153, v153
    s_nop 0
    v_add_f32 v150, 1.0, v150
    v_add_f32 v151, 1.0, v151
    v_add_f32 v152, 1.0, v152
    v_add_f32 v153, 1.0, v153
    v_rcp_f32 v150, v150
    v_rcp_f32 v151, v151
    v_rcp_f32 v152, v152
    v_rcp_f32 v153, v153
    s_nop 0
    v_mul_f32 v88, v88, v150
    v_mul_f32 v89, v89, v151
    v_mul_f32 v90, v90, v152
    v_mul_f32 v91, v91, v153
    v_cvt_pk_bf16_f32 v148, v88, v89
    v_cvt_pk_bf16_f32 v149, v90, v91
    v_lshlrev_b32 v88, 16, v148
    v_and_b32 v89, 0xffff0000, v148
    v_lshlrev_b32 v90, 16, v149
    v_and_b32 v91, 0xffff0000, v149
    v_mul_f32 v48, v48, v88
    v_mul_f32 v49, v49, v89
    v_mul_f32 v50, v50, v90
    v_mul_f32 v51, v51, v91
    v_add_f32 v48, v48, v52
    v_add_f32 v49, v49, v53
    v_add_f32 v50, v50, v54
    v_add_f32 v51, v51, v55
    buffer_store_dwordx4 v[48:51], v25, s[12:15], 0 offen offset:128 nt
    s_waitcnt lgkmcnt(1)
    v_add_f32 v96, v96, v100
    v_add_f32 v97, v97, v101
    v_add_f32 v98, v98, v102
    v_add_f32 v99, v99, v103
    v_cvt_pk_bf16_f32 v154, v96, v97
    v_cvt_pk_bf16_f32 v155, v98, v99
    v_lshlrev_b32 v96, 16, v154
    v_and_b32 v97, 0xffff0000, v154
    v_lshlrev_b32 v98, 16, v155
    v_and_b32 v99, 0xffff0000, v155
    v_mul_f32 v156, 0xbfb8aa3b, v96
    v_mul_f32 v157, 0xbfb8aa3b, v97
    v_mul_f32 v158, 0xbfb8aa3b, v98
    v_mul_f32 v159, 0xbfb8aa3b, v99
    v_exp_f32 v156, v156
    v_exp_f32 v157, v157
    v_exp_f32 v158, v158
    v_exp_f32 v159, v159
    s_nop 0
    v_add_f32 v156, 1.0, v156
    v_add_f32 v157, 1.0, v157
    v_add_f32 v158, 1.0, v158
    v_add_f32 v159, 1.0, v159
    v_rcp_f32 v156, v156
    v_rcp_f32 v157, v157
    v_rcp_f32 v158, v158
    v_rcp_f32 v159, v159
    s_nop 0
    v_mul_f32 v96, v96, v156
    v_mul_f32 v97, v97, v157
    v_mul_f32 v98, v98, v158
    v_mul_f32 v99, v99, v159
    v_cvt_pk_bf16_f32 v154, v96, v97
    v_cvt_pk_bf16_f32 v155, v98, v99
    v_lshlrev_b32 v96, 16, v154
    v_and_b32 v97, 0xffff0000, v154
    v_lshlrev_b32 v98, 16, v155
    v_and_b32 v99, 0xffff0000, v155
    v_mul_f32 v56, v56, v96
    v_mul_f32 v57, v57, v97
    v_mul_f32 v58, v58, v98
    v_mul_f32 v59, v59, v99
    v_add_f32 v56, v56, v60
    v_add_f32 v57, v57, v61
    v_add_f32 v58, v58, v62
    v_add_f32 v59, v59, v63
    buffer_store_dwordx4 v[56:59], v25, s[12:15], 0 offen offset:192 nt
    s_waitcnt lgkmcnt(0)
    v_add_f32 v104, v104, v108
    v_add_f32 v105, v105, v109
    v_add_f32 v106, v106, v110
    v_add_f32 v107, v107, v111
    v_cvt_pk_bf16_f32 v160, v104, v105
    v_cvt_pk_bf16_f32 v161, v106, v107
    v_lshlrev_b32 v104, 16, v160
    v_and_b32 v105, 0xffff0000, v160
    v_lshlrev_b32 v106, 16, v161
    v_and_b32 v107, 0xffff0000, v161
    v_mul_f32 v162, 0xbfb8aa3b, v104
    v_mul_f32 v163, 0xbfb8aa3b, v105
    v_mul_f32 v164, 0xbfb8aa3b, v106
    v_mul_f32 v165, 0xbfb8aa3b, v107
    v_exp_f32 v162, v162
    v_exp_f32 v163, v163
    v_exp_f32 v164, v164
    v_exp_f32 v165, v165
    s_nop 0
    v_add_f32 v162, 1.0, v162
    v_add_f32 v163, 1.0, v163
    v_add_f32 v164, 1.0, v164
    v_add_f32 v165, 1.0, v165
    v_rcp_f32 v162, v162
    v_rcp_f32 v163, v163
    v_rcp_f32 v164, v164
    v_rcp_f32 v165, v165
    s_nop 0
    v_mul_f32 v104, v104, v162
    v_mul_f32 v105, v105, v163
    v_mul_f32 v106, v106, v164
    v_mul_f32 v107, v107, v165
    v_cvt_pk_bf16_f32 v160, v104, v105
    v_cvt_pk_bf16_f32 v161, v106, v107
    v_lshlrev_b32 v104, 16, v160
    v_and_b32 v105, 0xffff0000, v160
    v_lshlrev_b32 v106, 16, v161
    v_and_b32 v107, 0xffff0000, v161
    v_mul_f32 v64, v64, v104
    v_mul_f32 v65, v65, v105
    v_mul_f32 v66, v66, v106
    v_mul_f32 v67, v67, v107
    v_add_f32 v64, v64, v68
    v_add_f32 v65, v65, v69
    v_add_f32 v66, v66, v70
    v_add_f32 v67, v67, v71
    buffer_store_dwordx4 v[64:67], v25, s[12:15], 0 offen offset:256 nt
    s_endpgm
k2_epi1:
    ds_write_b128 v20, v[72:75] offset:0
    ds_write_b128 v20, v[80:83] offset:1024
    ds_write_b128 v20, v[88:91] offset:2048
    ds_write_b128 v20, v[96:99] offset:3072
    ds_write_b128 v20, v[104:107] offset:4096
    s_waitcnt lgkmcnt(0)
    s_barrier
    ds_read_b128 v[72:75], v21 offset:0
    ds_read_b128 v[80:83], v21 offset:1024
    ds_read_b128 v[88:91], v21 offset:2048
    ds_read_b128 v[96:99], v21 offset:3072
    ds_read_b128 v[104:107], v21 offset:4096
    s_waitcnt lgkmcnt(4)
    v_add_f32 v76, v76, v72
    v_add_f32 v77, v77, v73
    v_add_f32 v78, v78, v74
    v_add_f32 v79, v79, v75
    v_cvt_pk_bf16_f32 v136, v76, v77
    v_cvt_pk_bf16_f32 v137, v78, v79
    v_lshlrev_b32 v76, 16, v136
    v_and_b32 v77, 0xffff0000, v136
    v_lshlrev_b32 v78, 16, v137
    v_and_b32 v79, 0xffff0000, v137
    v_mul_f32 v138, 0xbfb8aa3b, v76
    v_mul_f32 v139, 0xbfb8aa3b, v77
    v_mul_f32 v140, 0xbfb8aa3b, v78
    v_mul_f32 v141, 0xbfb8aa3b, v79
    v_exp_f32 v138, v138
    v_exp_f32 v139, v139
    v_exp_f32 v140, v140
    v_exp_f32 v141, v141
    s_nop 0
    v_add_f32 v138, 1.0, v138
    v_add_f32 v139, 1.0, v139
    v_add_f32 v140, 1.0, v140
    v_add_f32 v141, 1.0, v141
    v_rcp_f32 v138, v138
    v_rcp_f32 v139, v139
    v_rcp_f32 v140, v140
    v_rcp_f32 v141, v141
    s_nop 0
    v_mul_f32 v76, v76, v138
    v_mul_f32 v77, v77, v139
    v_mul_f32 v78, v78, v140
    v_mul_f32 v79, v79, v141
    v_cvt_pk_bf16_f32 v136, v76, v77
    v_cvt_pk_bf16_f32 v137, v78, v79
    v_lshlrev_b32 v76, 16, v136
    v_and_b32 v77, 0xffff0000, v136
    v_lshlrev_b32 v78, 16, v137
    v_and_b32 v79, 0xffff0000, v137
    v_mul_f32 v32, v32, v76
    v_mul_f32 v33, v33, v77
    v_mul_f32 v34, v34, v78
    v_mul_f32 v35, v35, v79
    v_add_f32 v32, v32, v36
    v_add_f32 v33, v33, v37
    v_add_f32 v34, v34, v38
    v_add_f32 v35, v35, v39
    buffer_store_dwordx4 v[32:35], v25, s[12:15], 0 offen offset:0 nt
    s_waitcnt lgkmcnt(3)
    v_add_f32 v84, v84, v80
    v_add_f32 v85, v85, v81
    v_add_f32 v86, v86, v82
    v_add_f32 v87, v87, v83
    v_cvt_pk_bf16_f32 v142, v84, v85
    v_cvt_pk_bf16_f32 v143, v86, v87
    v_lshlrev_b32 v84, 16, v142
    v_and_b32 v85, 0xffff0000, v142
    v_lshlrev_b32 v86, 16, v143
    v_and_b32 v87, 0xffff0000, v143
    v_mul_f32 v144, 0xbfb8aa3b, v84
    v_mul_f32 v145, 0xbfb8aa3b, v85
    v_mul_f32 v146, 0xbfb8aa3b, v86
    v_mul_f32 v147, 0xbfb8aa3b, v87
    v_exp_f32 v144, v144
    v_exp_f32 v145, v145
    v_exp_f32 v146, v146
    v_exp_f32 v147, v147
    s_nop 0
    v_add_f32 v144, 1.0, v144
    v_add_f32 v145, 1.0, v145
    v_add_f32 v146, 1.0, v146
    v_add_f32 v147, 1.0, v147
    v_rcp_f32 v144, v144
    v_rcp_f32 v145, v145
    v_rcp_f32 v146, v146
    v_rcp_f32 v147, v147
    s_nop 0
    v_mul_f32 v84, v84, v144
    v_mul_f32 v85, v85, v145
    v_mul_f32 v86, v86, v146
    v_mul_f32 v87, v87, v147
    v_cvt_pk_bf16_f32 v142, v84, v85
    v_cvt_pk_bf16_f32 v143, v86, v87
    v_lshlrev_b32 v84, 16, v142
    v_and_b32 v85, 0xffff0000, v142
    v_lshlrev_b32 v86, 16, v143
    v_and_b32 v87, 0xffff0000, v143
    v_mul_f32 v40, v40, v84
    v_mul_f32 v41, v41, v85
    v_mul_f32 v42, v42, v86
    v_mul_f32 v43, v43, v87
    v_add_f32 v40, v40, v44
    v_add_f32 v41, v41, v45
    v_add_f32 v42, v42, v46
    v_add_f32 v43, v43, v47
    buffer_store_dwordx4 v[40:43], v25, s[12:15], 0 offen offset:64 nt
    s_waitcnt lgkmcnt(2)
    v_add_f32 v92, v92, v88
    v_add_f32 v93, v93, v89
    v_add_f32 v94, v94, v90
    v_add_f32 v95, v95, v91
    v_cvt_pk_bf16_f32 v148, v92, v93
    v_cvt_pk_bf16_f32 v149, v94, v95
    v_lshlrev_b32 v92, 16, v148
    v_and_b32 v93, 0xffff0000, v148
    v_lshlrev_b32 v94, 16, v149
    v_and_b32 v95, 0xffff0000, v149
    v_mul_f32 v150, 0xbfb8aa3b, v92
    v_mul_f32 v151, 0xbfb8aa3b, v93
    v_mul_f32 v152, 0xbfb8aa3b, v94
    v_mul_f32 v153, 0xbfb8aa3b, v95
    v_exp_f32 v150, v150
    v_exp_f32 v151, v151
    v_exp_f32 v152, v152
    v_exp_f32 v153, v153
    s_nop 0
    v_add_f32 v150, 1.0, v150
    v_add_f32 v151, 1.0, v151
    v_add_f32 v152, 1.0, v152
    v_add_f32 v153, 1.0, v153
    v_rcp_f32 v150, v150
    v_rcp_f32 v151, v151
    v_rcp_f32 v152, v152
    v_rcp_f32 v153, v153
    s_nop 0
    v_mul_f32 v92, v92, v150
    v_mul_f32 v93, v93, v151
    v_mul_f32 v94, v94, v152
    v_mul_f32 v95, v95, v153
    v_cvt_pk_bf16_f32 v148, v92, v93
    v_cvt_pk_bf16_f32 v149, v94, v95
    v_lshlrev_b32 v92, 16, v148
    v_and_b32 v93, 0xffff0000, v148
    v_lshlrev_b32 v94, 16, v149
    v_and_b32 v95, 0xffff0000, v149
    v_mul_f32 v48, v48, v92
    v_mul_f32 v49, v49, v93
    v_mul_f32 v50, v50, v94
    v_mul_f32 v51, v51, v95
    v_add_f32 v48, v48, v52
    v_add_f32 v49, v49, v53
    v_add_f32 v50, v50, v54
    v_add_f32 v51, v51, v55
    buffer_store_dwordx4 v[48:51], v25, s[12:15], 0 offen offset:128 nt
    s_waitcnt lgkmcnt(1)
    v_add_f32 v100, v100, v96
    v_add_f32 v101, v101, v97
    v_add_f32 v102, v102, v98
    v_add_f32 v103, v103, v99
    v_cvt_pk_bf16_f32 v154, v100, v101
    v_cvt_pk_bf16_f32 v155, v102, v103
    v_lshlrev_b32 v100, 16, v154
    v_and_b32 v101, 0xffff0000, v154
    v_lshlrev_b32 v102, 16, v155
    v_and_b32 v103, 0xffff0000, v155
    v_mul_f32 v156, 0xbfb8aa3b, v100
    v_mul_f32 v157, 0xbfb8aa3b, v101
    v_mul_f32 v158, 0xbfb8aa3b, v102
    v_mul_f32 v159, 0xbfb8aa3b, v103
    v_exp_f32 v156, v156
    v_exp_f32 v157, v157
    v_exp_f32 v158, v158
    v_exp_f32 v159, v159
    s_nop 0
    v_add_f32 v156, 1.0, v156
    v_add_f32 v157, 1.0, v157
    v_add_f32 v158, 1.0, v158
    v_add_f32 v159, 1.0, v159
    v_rcp_f32 v156, v156
    v_rcp_f32 v157, v157
    v_rcp_f32 v158, v158
    v_rcp_f32 v159, v159
    s_nop 0
    v_mul_f32 v100, v100, v156
    v_mul_f32 v101, v101, v157
    v_mul_f32 v102, v102, v158
    v_mul_f32 v103, v103, v159
    v_cvt_pk_bf16_f32 v154, v100, v101
    v_cvt_pk_bf16_f32 v155, v102, v103
    v_lshlrev_b32 v100, 16, v154
    v_and_b32 v101, 0xffff0000, v154
    v_lshlrev_b32 v102, 16, v155
    v_and_b32 v103, 0xffff0000, v155
    v_mul_f32 v56, v56, v100
    v_mul_f32 v57, v57, v101
    v_mul_f32 v58, v58, v102
    v_mul_f32 v59, v59, v103
    v_add_f32 v56, v56, v60
    v_add_f32 v57, v57, v61
    v_add_f32 v58, v58, v62
    v_add_f32 v59, v59, v63
    buffer_store_dwordx4 v[56:59], v25, s[12:15], 0 offen offset:192 nt
    s_waitcnt lgkmcnt(0)
    v_add_f32 v108, v108, v104
    v_add_f32 v109, v109, v105
    v_add_f32 v110, v110, v106
    v_add_f32 v111, v111, v107
    v_cvt_pk_bf16_f32 v160, v108, v109
    v_cvt_pk_bf16_f32 v161, v110, v111
    v_lshlrev_b32 v108, 16, v160
    v_and_b32 v109, 0xffff0000, v160
    v_lshlrev_b32 v110, 16, v161
    v_and_b32 v111, 0xffff0000, v161
    v_mul_f32 v162, 0xbfb8aa3b, v108
    v_mul_f32 v163, 0xbfb8aa3b, v109
    v_mul_f32 v164, 0xbfb8aa3b, v110
    v_mul_f32 v165, 0xbfb8aa3b, v111
    v_exp_f32 v162, v162
    v_exp_f32 v163, v163
    v_exp_f32 v164, v164
    v_exp_f32 v165, v165
    s_nop 0
    v_add_f32 v162, 1.0, v162
    v_add_f32 v163, 1.0, v163
    v_add_f32 v164, 1.0, v164
    v_add_f32 v165, 1.0, v165
    v_rcp_f32 v162, v162
    v_rcp_f32 v163, v163
    v_rcp_f32 v164, v164
    v_rcp_f32 v165, v165
    s_nop 0
    v_mul_f32 v108, v108, v162
    v_mul_f32 v109, v109, v163
    v_mul_f32 v110, v110, v164
    v_mul_f32 v111, v111, v165
    v_cvt_pk_bf16_f32 v160, v108, v109
    v_cvt_pk_bf16_f32 v161, v110, v111
    v_lshlrev_b32 v108, 16, v160
    v_and_b32 v109, 0xffff0000, v160
    v_lshlrev_b32 v110, 16, v161
    v_and_b32 v111, 0xffff0000, v161
    v_mul_f32 v64, v64, v108
    v_mul_f32 v65, v65, v109
    v_mul_f32 v66, v66, v110
    v_mul_f32 v67, v67, v111
    v_add_f32 v64, v64, v68
    v_add_f32 v65, v65, v69
    v_add_f32 v66, v66, v70
    v_add_f32 v67, v67, v71
    buffer_store_dwordx4 v[64:67], v25, s[12:15], 0 offen offset:256 nt
    s_endpgm
k2_loader:
    s_setprio 3
    s_sub_u32 s42, s42, 4
    v_and_b32 v1, 63, v0
    v_lshlrev_b32 v2, 4, v1
    s_lshl_b32 s48, s42, 11
    v_add_u32 v4, s48, v2
    v_add_u32 v5, 1024, v4
    s_mul_i32 s50, s42, 3
    s_lshl_b32 s51, s42, 1
    s_add_u32 s51, s51, 2
    s_cmp_ge_u32 s42, 2
    s_cselect_b32 s56, s51, s50
    s_lshl_b32 s57, s56, 10
    s_add_u32 s49, s57, 8192
    v_add_u32 v10, s57, v2
    v_add_u32 v11, s57, v2
    v_add_u32 v11, 1024, v11
    v_add_u32 v12, s57, v2
    v_add_u32 v12, 2048, v12
    s_mul_i32 s45, s40, 385024
    s_mul_i32 s46, s41, 481280
    s_mov_b32 s44, 0
    s_waitcnt lgkmcnt(0)
    s_add_u32 s8, s4, 2637824
    s_addc_u32 s9, s5, 0
    s_mov_b32 s10, 12320768
    s_mov_b32 s11, 0x00020000
    s_add_u32 s12, s4, 15093760
    s_addc_u32 s13, s5, 0
    s_mov_b32 s14, 3850240
    s_mov_b32 s15, 0x00020000
    s_cmp_ge_u32 s42, 2
    s_cbranch_scc1 k2_loader_2
    s_add_u32 s50, s44, s48
    s_add_u32 m0, s50, 0
    s_nop 0
    buffer_load_dwordx4 v4, s[8:11], s45 offen lds
    s_add_u32 m0, s50, 1024
    s_nop 0
    buffer_load_dwordx4 v5, s[8:11], s45 offen lds
    s_add_u32 s50, s44, s49
    s_add_u32 m0, s50, 0
    s_nop 0
    buffer_load_dwordx4 v10, s[12:15], s46 offen lds
    s_add_u32 m0, s50, 1024
    s_nop 0
    buffer_load_dwordx4 v11, s[12:15], s46 offen lds
    s_add_u32 m0, s50, 2048
    s_nop 0
    buffer_load_dwordx4 v12, s[12:15], s46 offen lds
    s_add_u32 s45, s45, 8192
    s_add_u32 s46, s46, 10240
    s_add_u32 s44, s44, 18432
    s_cmp_eq_u32 s44, 129024
    s_cselect_b32 s44, 0, s44
    s_add_u32 s50, s44, s48
    s_add_u32 m0, s50, 0
    s_nop 0
    buffer_load_dwordx4 v4, s[8:11], s45 offen lds
    s_add_u32 m0, s50, 1024
    s_nop 0
    buffer_load_dwordx4 v5, s[8:11], s45 offen lds
    s_add_u32 s50, s44, s49
    s_add_u32 m0, s50, 0
    s_nop 0
    buffer_load_dwordx4 v10, s[12:15], s46 offen lds
    s_add_u32 m0, s50, 1024
    s_nop 0
    buffer_load_dwordx4 v11, s[12:15], s46 offen lds
    s_add_u32 m0, s50, 2048
    s_nop 0
    buffer_load_dwordx4 v12, s[12:15], s46 offen lds
    s_add_u32 s45, s45, 8192
    s_add_u32 s46, s46, 10240
    s_add_u32 s44, s44, 18432
    s_cmp_eq_u32 s44, 129024
    s_cselect_b32 s44, 0, s44
    s_waitcnt vmcnt(5)
    s_barrier
    s_add_u32 s50, s44, s48
    s_add_u32 m0, s50, 0
    s_nop 0
    buffer_load_dwordx4 v4, s[8:11], s45 offen lds
    s_add_u32 m0, s50, 1024
    s_nop 0
    buffer_load_dwordx4 v5, s[8:11], s45 offen lds
    s_add_u32 s50, s44, s49
    s_add_u32 m0, s50, 0
    s_nop 0
    buffer_load_dwordx4 v10, s[12:15], s46 offen lds
    s_add_u32 m0, s50, 1024
    s_nop 0
    buffer_load_dwordx4 v11, s[12:15], s46 offen lds
    s_add_u32 m0, s50, 2048
    s_nop 0
    buffer_load_dwordx4 v12, s[12:15], s46 offen lds
    s_add_u32 s45, s45, 8192
    s_add_u32 s46, s46, 10240
    s_add_u32 s44, s44, 18432
    s_cmp_eq_u32 s44, 129024
    s_cselect_b32 s44, 0, s44
    s_add_u32 s50, s44, s48
    s_add_u32 m0, s50, 0
    s_nop 0
    buffer_load_dwordx4 v4, s[8:11], s45 offen lds
    s_add_u32 m0, s50, 1024
    s_nop 0
    buffer_load_dwordx4 v5, s[8:11], s45 offen lds
    s_add_u32 s50, s44, s49
    s_add_u32 m0, s50, 0
    s_nop 0
    buffer_load_dwordx4 v10, s[12:15], s46 offen lds
    s_add_u32 m0, s50, 1024
    s_nop 0
    buffer_load_dwordx4 v11, s[12:15], s46 offen lds
    s_add_u32 m0, s50, 2048
    s_nop 0
    buffer_load_dwordx4 v12, s[12:15], s46 offen lds
    s_add_u32 s45, s45, 8192
    s_add_u32 s46, s46, 10240
    s_add_u32 s44, s44, 18432
    s_cmp_eq_u32 s44, 129024
    s_cselect_b32 s44, 0, s44
    s_waitcnt vmcnt(10)
    s_barrier
    s_add_u32 s50, s44, s48
    s_add_u32 m0, s50, 0
    s_nop 0
    buffer_load_dwordx4 v4, s[8:11], s45 offen lds
    s_add_u32 m0, s50, 1024
    s_nop 0
    buffer_load_dwordx4 v5, s[8:11], s45 offen lds
    s_add_u32 s50, s44, s49
    s_add_u32 m0, s50, 0
    s_nop 0
    buffer_load_dwordx4 v10, s[12:15], s46 offen lds
    s_add_u32 m0, s50, 1024
    s_nop 0
    buffer_load_dwordx4 v11, s[12:15], s46 offen lds
    s_add_u32 m0, s50, 2048
    s_nop 0
    buffer_load_dwordx4 v12, s[12:15], s46 offen lds
    s_add_u32 s45, s45, 8192
    s_add_u32 s46, s46, 10240
    s_add_u32 s44, s44, 18432
    s_cmp_eq_u32 s44, 129024
    s_cselect_b32 s44, 0, s44
    s_add_u32 s50, s44, s48
    s_add_u32 m0, s50, 0
    s_nop 0
    buffer_load_dwordx4 v4, s[8:11], s45 offen lds
    s_add_u32 m0, s50, 1024
    s_nop 0
    buffer_load_dwordx4 v5, s[8:11], s45 offen lds
    s_add_u32 s50, s44, s49
    s_add_u32 m0, s50, 0
    s_nop 0
    buffer_load_dwordx4 v10, s[12:15], s46 offen lds
    s_add_u32 m0, s50, 1024
    s_nop 0
    buffer_load_dwordx4 v11, s[12:15], s46 offen lds
    s_add_u32 m0, s50, 2048
    s_nop 0
    buffer_load_dwordx4 v12, s[12:15], s46 offen lds
    s_add_u32 s45, s45, 8192
    s_add_u32 s46, s46, 10240
    s_add_u32 s44, s44, 18432
    s_cmp_eq_u32 s44, 129024
    s_cselect_b32 s44, 0, s44
    s_waitcnt vmcnt(15)
    s_barrier
    s_add_u32 s50, s44, s48
    s_add_u32 m0, s50, 0
    s_nop 0
    buffer_load_dwordx4 v4, s[8:11], s45 offen lds
    s_add_u32 m0, s50, 1024
    s_nop 0
    buffer_load_dwordx4 v5, s[8:11], s45 offen lds
    s_add_u32 s50, s44, s49
    s_add_u32 m0, s50, 0
    s_nop 0
    buffer_load_dwordx4 v10, s[12:15], s46 offen lds
    s_add_u32 m0, s50, 1024
    s_nop 0
    buffer_load_dwordx4 v11, s[12:15], s46 offen lds
    s_add_u32 m0, s50, 2048
    s_nop 0
    buffer_load_dwordx4 v12, s[12:15], s46 offen lds
    s_add_u32 s45, s45, 8192
    s_add_u32 s46, s46, 10240
    s_add_u32 s44, s44, 18432
    s_cmp_eq_u32 s44, 129024
    s_cselect_b32 s44, 0, s44
    s_add_u32 s50, s44, s48
    s_add_u32 m0, s50, 0
    s_nop 0
    buffer_load_dwordx4 v4, s[8:11], s45 offen lds
    s_add_u32 m0, s50, 1024
    s_nop 0
    buffer_load_dwordx4 v5, s[8:11], s45 offen lds
    s_add_u32 s50, s44, s49
    s_add_u32 m0, s50, 0
    s_nop 0
    buffer_load_dwordx4 v10, s[12:15], s46 offen lds
    s_add_u32 m0, s50, 1024
    s_nop 0
    buffer_load_dwordx4 v11, s[12:15], s46 offen lds
    s_add_u32 m0, s50, 2048
    s_nop 0
    buffer_load_dwordx4 v12, s[12:15], s46 offen lds
    s_add_u32 s45, s45, 8192
    s_add_u32 s46, s46, 10240
    s_add_u32 s44, s44, 18432
    s_cmp_eq_u32 s44, 129024
    s_cselect_b32 s44, 0, s44
    s_waitcnt vmcnt(20)
    s_barrier
    s_add_u32 s50, s44, s48
    s_add_u32 m0, s50, 0
    s_nop 0
    buffer_load_dwordx4 v4, s[8:11], s45 offen lds
    s_add_u32 m0, s50, 1024
    s_nop 0
    buffer_load_dwordx4 v5, s[8:11], s45 offen lds
    s_add_u32 s50, s44, s49
    s_add_u32 m0, s50, 0
    s_nop 0
    buffer_load_dwordx4 v10, s[12:15], s46 offen lds
    s_add_u32 m0, s50, 1024
    s_nop 0
    buffer_load_dwordx4 v11, s[12:15], s46 offen lds
    s_add_u32 m0, s50, 2048
    s_nop 0
    buffer_load_dwordx4 v12, s[12:15], s46 offen lds
    s_add_u32 s45, s45, 8192
    s_add_u32 s46, s46, 10240
    s_add_u32 s44, s44, 18432
    s_cmp_eq_u32 s44, 129024
    s_cselect_b32 s44, 0, s44
    s_add_u32 s50, s44, s48
    s_add_u32 m0, s50, 0
    s_nop 0
    buffer_load_dwordx4 v4, s[8:11], s45 offen lds
    s_add_u32 m0, s50, 1024
    s_nop 0
    buffer_load_dwordx4 v5, s[8:11], s45 offen lds
    s_add_u32 s50, s44, s49
    s_add_u32 m0, s50, 0
    s_nop 0
    buffer_load_dwordx4 v10, s[12:15], s46 offen lds
    s_add_u32 m0, s50, 1024
    s_nop 0
    buffer_load_dwordx4 v11, s[12:15], s46 offen lds
    s_add_u32 m0, s50, 2048
    s_nop 0
    buffer_load_dwordx4 v12, s[12:15], s46 offen lds
    s_add_u32 s45, s45, 8192
    s_add_u32 s46, s46, 10240
    s_add_u32 s44, s44, 18432
    s_cmp_eq_u32 s44, 129024
    s_cselect_b32 s44, 0, s44
    s_waitcnt vmcnt(25)
    s_barrier
    s_mov_b32 s52, 5
k2_3_ld_loop:
    s_add_u32 s50, s44, s48
    s_add_u32 m0, s50, 0
    s_nop 0
    buffer_load_dwordx4 v4, s[8:11], s45 offen lds
    s_add_u32 m0, s50, 1024
    s_nop 0
    buffer_load_dwordx4 v5, s[8:11], s45 offen lds
    s_add_u32 s50, s44, s49
    s_add_u32 m0, s50, 0
    s_nop 0
    buffer_load_dwordx4 v10, s[12:15], s46 offen lds
    s_add_u32 m0, s50, 1024
    s_nop 0
    buffer_load_dwordx4 v11, s[12:15], s46 offen lds
    s_add_u32 m0, s50, 2048
    s_nop 0
    buffer_load_dwordx4 v12, s[12:15], s46 offen lds
    s_add_u32 s45, s45, 8192
    s_add_u32 s46, s46, 10240
    s_add_u32 s44, s44, 18432
    s_cmp_eq_u32 s44, 129024
    s_cselect_b32 s44, 0, s44
    s_waitcnt vmcnt(25)
    s_barrier
    s_add_u32 s52, s52, 1
    s_cmp_le_u32 s52, 41
    s_cbranch_scc1 k2_3_ld_loop
    s_waitcnt vmcnt(20)
    s_barrier
    s_waitcnt vmcnt(15)
    s_barrier
    s_waitcnt vmcnt(10)
    s_barrier
    s_waitcnt vmcnt(5)
    s_barrier
    s_waitcnt vmcnt(0)
    s_barrier
    s_barrier
    s_endpgm
k2_loader_2:
    s_add_u32 s50, s44, s48
    s_add_u32 m0, s50, 0
    s_nop 0
    buffer_load_dwordx4 v4, s[8:11], s45 offen lds
    s_add_u32 m0, s50, 1024
    s_nop 0
    buffer_load_dwordx4 v5, s[8:11], s45 offen lds
    s_add_u32 s50, s44, s49
    s_add_u32 m0, s50, 0
    s_nop 0
    buffer_load_dwordx4 v10, s[12:15], s46 offen lds
    s_add_u32 m0, s50, 1024
    s_nop 0
    buffer_load_dwordx4 v11, s[12:15], s46 offen lds
    s_add_u32 s45, s45, 8192
    s_add_u32 s46, s46, 10240
    s_add_u32 s44, s44, 18432
    s_cmp_eq_u32 s44, 129024
    s_cselect_b32 s44, 0, s44
    s_add_u32 s50, s44, s48
    s_add_u32 m0, s50, 0
    s_nop 0
    buffer_load_dwordx4 v4, s[8:11], s45 offen lds
    s_add_u32 m0, s50, 1024
    s_nop 0
    buffer_load_dwordx4 v5, s[8:11], s45 offen lds
    s_add_u32 s50, s44, s49
    s_add_u32 m0, s50, 0
    s_nop 0
    buffer_load_dwordx4 v10, s[12:15], s46 offen lds
    s_add_u32 m0, s50, 1024
    s_nop 0
    buffer_load_dwordx4 v11, s[12:15], s46 offen lds
    s_add_u32 s45, s45, 8192
    s_add_u32 s46, s46, 10240
    s_add_u32 s44, s44, 18432
    s_cmp_eq_u32 s44, 129024
    s_cselect_b32 s44, 0, s44
    s_waitcnt vmcnt(4)
    s_barrier
    s_add_u32 s50, s44, s48
    s_add_u32 m0, s50, 0
    s_nop 0
    buffer_load_dwordx4 v4, s[8:11], s45 offen lds
    s_add_u32 m0, s50, 1024
    s_nop 0
    buffer_load_dwordx4 v5, s[8:11], s45 offen lds
    s_add_u32 s50, s44, s49
    s_add_u32 m0, s50, 0
    s_nop 0
    buffer_load_dwordx4 v10, s[12:15], s46 offen lds
    s_add_u32 m0, s50, 1024
    s_nop 0
    buffer_load_dwordx4 v11, s[12:15], s46 offen lds
    s_add_u32 s45, s45, 8192
    s_add_u32 s46, s46, 10240
    s_add_u32 s44, s44, 18432
    s_cmp_eq_u32 s44, 129024
    s_cselect_b32 s44, 0, s44
    s_add_u32 s50, s44, s48
    s_add_u32 m0, s50, 0
    s_nop 0
    buffer_load_dwordx4 v4, s[8:11], s45 offen lds
    s_add_u32 m0, s50, 1024
    s_nop 0
    buffer_load_dwordx4 v5, s[8:11], s45 offen lds
    s_add_u32 s50, s44, s49
    s_add_u32 m0, s50, 0
    s_nop 0
    buffer_load_dwordx4 v10, s[12:15], s46 offen lds
    s_add_u32 m0, s50, 1024
    s_nop 0
    buffer_load_dwordx4 v11, s[12:15], s46 offen lds
    s_add_u32 s45, s45, 8192
    s_add_u32 s46, s46, 10240
    s_add_u32 s44, s44, 18432
    s_cmp_eq_u32 s44, 129024
    s_cselect_b32 s44, 0, s44
    s_waitcnt vmcnt(8)
    s_barrier
    s_add_u32 s50, s44, s48
    s_add_u32 m0, s50, 0
    s_nop 0
    buffer_load_dwordx4 v4, s[8:11], s45 offen lds
    s_add_u32 m0, s50, 1024
    s_nop 0
    buffer_load_dwordx4 v5, s[8:11], s45 offen lds
    s_add_u32 s50, s44, s49
    s_add_u32 m0, s50, 0
    s_nop 0
    buffer_load_dwordx4 v10, s[12:15], s46 offen lds
    s_add_u32 m0, s50, 1024
    s_nop 0
    buffer_load_dwordx4 v11, s[12:15], s46 offen lds
    s_add_u32 s45, s45, 8192
    s_add_u32 s46, s46, 10240
    s_add_u32 s44, s44, 18432
    s_cmp_eq_u32 s44, 129024
    s_cselect_b32 s44, 0, s44
    s_add_u32 s50, s44, s48
    s_add_u32 m0, s50, 0
    s_nop 0
    buffer_load_dwordx4 v4, s[8:11], s45 offen lds
    s_add_u32 m0, s50, 1024
    s_nop 0
    buffer_load_dwordx4 v5, s[8:11], s45 offen lds
    s_add_u32 s50, s44, s49
    s_add_u32 m0, s50, 0
    s_nop 0
    buffer_load_dwordx4 v10, s[12:15], s46 offen lds
    s_add_u32 m0, s50, 1024
    s_nop 0
    buffer_load_dwordx4 v11, s[12:15], s46 offen lds
    s_add_u32 s45, s45, 8192
    s_add_u32 s46, s46, 10240
    s_add_u32 s44, s44, 18432
    s_cmp_eq_u32 s44, 129024
    s_cselect_b32 s44, 0, s44
    s_waitcnt vmcnt(12)
    s_barrier
    s_add_u32 s50, s44, s48
    s_add_u32 m0, s50, 0
    s_nop 0
    buffer_load_dwordx4 v4, s[8:11], s45 offen lds
    s_add_u32 m0, s50, 1024
    s_nop 0
    buffer_load_dwordx4 v5, s[8:11], s45 offen lds
    s_add_u32 s50, s44, s49
    s_add_u32 m0, s50, 0
    s_nop 0
    buffer_load_dwordx4 v10, s[12:15], s46 offen lds
    s_add_u32 m0, s50, 1024
    s_nop 0
    buffer_load_dwordx4 v11, s[12:15], s46 offen lds
    s_add_u32 s45, s45, 8192
    s_add_u32 s46, s46, 10240
    s_add_u32 s44, s44, 18432
    s_cmp_eq_u32 s44, 129024
    s_cselect_b32 s44, 0, s44
    s_add_u32 s50, s44, s48
    s_add_u32 m0, s50, 0
    s_nop 0
    buffer_load_dwordx4 v4, s[8:11], s45 offen lds
    s_add_u32 m0, s50, 1024
    s_nop 0
    buffer_load_dwordx4 v5, s[8:11], s45 offen lds
    s_add_u32 s50, s44, s49
    s_add_u32 m0, s50, 0
    s_nop 0
    buffer_load_dwordx4 v10, s[12:15], s46 offen lds
    s_add_u32 m0, s50, 1024
    s_nop 0
    buffer_load_dwordx4 v11, s[12:15], s46 offen lds
    s_add_u32 s45, s45, 8192
    s_add_u32 s46, s46, 10240
    s_add_u32 s44, s44, 18432
    s_cmp_eq_u32 s44, 129024
    s_cselect_b32 s44, 0, s44
    s_waitcnt vmcnt(16)
    s_barrier
    s_add_u32 s50, s44, s48
    s_add_u32 m0, s50, 0
    s_nop 0
    buffer_load_dwordx4 v4, s[8:11], s45 offen lds
    s_add_u32 m0, s50, 1024
    s_nop 0
    buffer_load_dwordx4 v5, s[8:11], s45 offen lds
    s_add_u32 s50, s44, s49
    s_add_u32 m0, s50, 0
    s_nop 0
    buffer_load_dwordx4 v10, s[12:15], s46 offen lds
    s_add_u32 m0, s50, 1024
    s_nop 0
    buffer_load_dwordx4 v11, s[12:15], s46 offen lds
    s_add_u32 s45, s45, 8192
    s_add_u32 s46, s46, 10240
    s_add_u32 s44, s44, 18432
    s_cmp_eq_u32 s44, 129024
    s_cselect_b32 s44, 0, s44
    s_add_u32 s50, s44, s48
    s_add_u32 m0, s50, 0
    s_nop 0
    buffer_load_dwordx4 v4, s[8:11], s45 offen lds
    s_add_u32 m0, s50, 1024
    s_nop 0
    buffer_load_dwordx4 v5, s[8:11], s45 offen lds
    s_add_u32 s50, s44, s49
    s_add_u32 m0, s50, 0
    s_nop 0
    buffer_load_dwordx4 v10, s[12:15], s46 offen lds
    s_add_u32 m0, s50, 1024
    s_nop 0
    buffer_load_dwordx4 v11, s[12:15], s46 offen lds
    s_add_u32 s45, s45, 8192
    s_add_u32 s46, s46, 10240
    s_add_u32 s44, s44, 18432
    s_cmp_eq_u32 s44, 129024
    s_cselect_b32 s44, 0, s44
    s_waitcnt vmcnt(20)
    s_barrier
    s_mov_b32 s52, 5
k2_2_ld_loop:
    s_add_u32 s50, s44, s48
    s_add_u32 m0, s50, 0
    s_nop 0
    buffer_load_dwordx4 v4, s[8:11], s45 offen lds
    s_add_u32 m0, s50, 1024
    s_nop 0
    buffer_load_dwordx4 v5, s[8:11], s45 offen lds
    s_add_u32 s50, s44, s49
    s_add_u32 m0, s50, 0
    s_nop 0
    buffer_load_dwordx4 v10, s[12:15], s46 offen lds
    s_add_u32 m0, s50, 1024
    s_nop 0
    buffer_load_dwordx4 v11, s[12:15], s46 offen lds
    s_add_u32 s45, s45, 8192
    s_add_u32 s46, s46, 10240
    s_add_u32 s44, s44, 18432
    s_cmp_eq_u32 s44, 129024
    s_cselect_b32 s44, 0, s44
    s_waitcnt vmcnt(20)
    s_barrier
    s_add_u32 s52, s52, 1
    s_cmp_le_u32 s52, 41
    s_cbranch_scc1 k2_2_ld_loop
    s_waitcnt vmcnt(16)
    s_barrier
    s_waitcnt vmcnt(12)
    s_barrier
    s_waitcnt vmcnt(8)
    s_barrier
    s_waitcnt vmcnt(4)
    s_barrier
    s_waitcnt vmcnt(0)
    s_barrier
    s_barrier
    s_endpgm
k2_done:
    s_endpgm
code_end:
.section .rodata,"a"
.p2align 6
.amdhsa_kernel k0_kernel
  .amdhsa_next_free_vgpr 88
  .amdhsa_next_free_sgpr 100
  .amdhsa_accum_offset 88
  .amdhsa_group_segment_fixed_size 0
  .amdhsa_kernarg_size 120
  .amdhsa_user_sgpr_count 2
  .amdhsa_user_sgpr_kernarg_segment_ptr 1
  .amdhsa_system_sgpr_workgroup_id_x 1
  .amdhsa_float_denorm_mode_32 3
.end_amdhsa_kernel
.p2align 6
.amdhsa_kernel k1_kernel
  .amdhsa_next_free_vgpr 256
  .amdhsa_next_free_sgpr 100
  .amdhsa_accum_offset 256
  .amdhsa_group_segment_fixed_size 0
  .amdhsa_kernarg_size 120
  .amdhsa_user_sgpr_count 2
  .amdhsa_user_sgpr_kernarg_segment_ptr 1
  .amdhsa_system_sgpr_workgroup_id_x 1
  .amdhsa_float_denorm_mode_32 3
.end_amdhsa_kernel
.p2align 6
.amdhsa_kernel k2_kernel
  .amdhsa_next_free_vgpr 208
  .amdhsa_next_free_sgpr 100
  .amdhsa_accum_offset 208
  .amdhsa_group_segment_fixed_size 0
  .amdhsa_kernarg_size 120
  .amdhsa_user_sgpr_count 2
  .amdhsa_user_sgpr_kernarg_segment_ptr 1
  .amdhsa_system_sgpr_workgroup_id_x 1
  .amdhsa_float_denorm_mode_32 3
.end_amdhsa_kernel
```
